```python
import torch

def _softmax(x, axis=-1):
    return torch.softmax(x, dim=axis)
def _gelu(x):
    return torch.nn.functional.gelu(x, approximate="tanh")
def _silu(x):
    return torch.nn.functional.silu(x)
def _sigmoid(x):
    return torch.sigmoid(x)
def _layernorm(x, axis=-1, eps=1e-5):
    m = x.mean(dim=axis, keepdim=True)
    v = x.var(dim=axis, keepdim=True, unbiased=False)
    return (x - m) / torch.sqrt(v + eps)
def _scatter_add(tgt, idx, src, axis=0):
    return tgt.clone().index_add_(axis, idx, src)
def _segment_sum(src, seg, n):
    out = torch.zeros((n,) + src.shape[1:], dtype=src.dtype)
    return out.index_add_(0, seg, src)
def _pad(x, pw):
    flat = tuple(v for pair in reversed(pw) for v in pair)
    return torch.nn.functional.pad(x, flat)

kernel_name = 'standalone__gqa_softmax__near_ridge'

def setup_inputs():

    _w = (lambda a: (lambda t: t.to(torch.bfloat16) if t.is_floating_point() else t)(torch.as_tensor(a)))
    B, Hq, Hkv, Sq, Sk, D = 16, 32, 32, 368, 512, 192
    return {
        "q": _w((lambda *s: torch.randn(*s, dtype=torch.bfloat16) * 0.8)(B, Hq, Sq, D)),
        "k": _w((lambda *s: torch.randn(*s, dtype=torch.bfloat16) * 0.8)(B, Hkv, Sk, D)),
        "v": _w((lambda *s: torch.randn(*s, dtype=torch.bfloat16) * 0.05)(B, Hkv, Sk, D)),
    }

def reference(q, k, v):
    B, Hq, Sq, D = q.shape
    Hkv = k.shape[1]
    rep = Hq // Hkv
    k = (lambda x, n, axis: torch.repeat_interleave(x, n, dim=axis))(k, rep, axis=1)
    v = (lambda x, n, axis: torch.repeat_interleave(x, n, dim=axis))(v, rep, axis=1)
    scale = D ** -0.5
    scores = torch.einsum("bhqd,bhkd->bhqk", q, k) * scale
    p = _softmax(scores, axis=-1)
    return torch.einsum("bhqk,bhkd->bhqd", p, v)
```

```asm
; @launch grid=(256,1,1) block=(512,1,1) lds=163840
.amdgcn_target "amdgcn-amd-amdhsa--gfx950"
.text
.globl standalone__gqa_softmax__near_ridge_kernel
.p2align 8
.type standalone__gqa_softmax__near_ridge_kernel,@function
standalone__gqa_softmax__near_ridge_kernel:
    s_cmp_ge_u32 s2, 256
    s_cbranch_scc1 L_end
    s_load_dwordx4 s[52:55], s[0:1], 0
    s_load_dwordx4 s[56:59], s[0:1], 16
    s_mul_i32 s46, s2, 282624
    s_mul_i32 s47, s2, 393216
    v_lshrrev_b32 v211, 6, v0
    v_and_b32 v208, 63, v0
    v_readfirstlane_b32 s24, v211
    v_and_b32 v209, 15, v208
    v_lshrrev_b32 v210, 4, v208
    s_and_b32 s35, s24, 3
    s_mul_i32 s26, s35, 3072
    s_lshr_b32 s25, s24, 2
    s_mul_i32 s36, s24, 48
    s_mov_b32 s28, 0x3dd53b95
    v_lshrrev_b32 v211, 3, v208
    v_and_b32 v212, 6, v211
    v_and_b32 v213, 7, v208
    v_xor_b32 v212, v212, v213
    v_lshlrev_b32 v212, 4, v212
    v_mul_u32_u24 v211, 384, v211
    v_add_u32 v252, v211, v212
    v_lshrrev_b32 v211, 3, v209
    v_mul_u32_u24 v211, 3072, v211
    v_and_b32 v212, 7, v209
    v_lshlrev_b32 v212, 7, v212
    v_add_u32 v211, v211, v212
    v_and_b32 v212, 6, v209
    v_xor_b32 v212, v212, v210
    v_lshlrev_b32 v212, 4, v212
    v_add_u32 v250, v211, v212
    v_and_b32 v211, 1, v210
    v_lshlrev_b32 v211, 2, v211
    v_lshrrev_b32 v212, 2, v209
    v_add_u32 v211, v211, v212
    v_and_b32 v212, 6, v211
    v_bfe_u32 v213, v209, 1, 1
    v_or_b32 v212, v212, v213
    v_lshlrev_b32 v212, 4, v212
    v_lshlrev_b32 v211, 7, v211
    v_add_u32 v211, v211, v212
    v_and_b32 v212, 1, v209
    v_lshlrev_b32 v212, 3, v212
    v_add_u32 v211, v211, v212
    v_lshrrev_b32 v212, 1, v210
    v_mul_u32_u24 v212, 3072, v212
    v_add_u32 v211, v211, v212
    v_add_u32 v251, 12288, v211
    s_lshl_b32 s37, s24, 11
    s_add_u32 s37, s37, 147456
    v_lshlrev_b32 v211, 4, v208
    v_add_u32 v253, s37, v211
    v_mbcnt_lo_u32_b32 v212, -1, 0
    v_mbcnt_hi_u32_b32 v212, -1, v212
    v_and_b32 v211, 15, v212
    v_lshrrev_b32 v212, 4, v212
    v_add_u32 v211, s36, v211
    v_mul_u32_u24 v211, 384, v211
    v_lshlrev_b32 v212, 4, v212
    v_add_u32 v254, v211, v212
    s_waitcnt lgkmcnt(0)
    s_add_u32 s4, s52, s46
    s_addc_u32 s5, s53, 0
    s_and_b32 s5, s5, 0xffff
    s_mov_b32 s6, 141312
    s_mov_b32 s7, 0x20000
    s_add_u32 s12, s54, s47
    s_addc_u32 s13, s55, 0
    s_and_b32 s13, s13, 0xffff
    s_mov_b32 s14, 393216
    s_mov_b32 s15, 0x20000
    s_add_u32 s20, s56, s47
    s_addc_u32 s21, s57, 0
    s_and_b32 s21, s21, 0xffff
    s_mov_b32 s22, 393216
    s_mov_b32 s23, 0x20000
    s_add_u32 s16, s58, s46
    s_addc_u32 s17, s59, 0
    s_and_b32 s17, s17, 0xffff
    s_mov_b32 s18, 141312
    s_mov_b32 s19, 0x20000
    s_cmp_eq_u32 s25, 0
    s_cselect_b32 s38, s20, s12
    s_cselect_b32 s39, s21, s13
    s_cselect_b32 s27, 12288, 0
    s_add_u32 s27, s27, s26
    s_mov_b32 s8, s38
    s_mov_b32 s9, s39
    s_mov_b32 s10, 393216
    s_mov_b32 s11, 0x20000
    s_add_u32 s40, s4, 141312
    s_addc_u32 s41, s5, 0
    s_mul_i32 s43, s25, 3
    s_sub_u32 s42, s43, 13
    s_add_u32 s43, s43, 3
    s_cmp_eq_u32 s25, 0
    s_cselect_b32 s51, 0x3000e, 1
    s_mov_b32 s3, 141312
    s_mov_b32 s100, 393216
    s_mov_b32 s44, s27
    s_cmp_lg_u32 s25, 0
    s_cbranch_scc1 L_pro_gb
    s_add_u32 s46, s26, 0
    s_add_u32 s47, s26, 0
    s_add_u32 m0, s47, 0
    s_nop 0
    buffer_load_dwordx4 v252, s[12:15], s46 offen offset:0 nt lds
    s_add_u32 m0, s47, 896
    s_nop 0
    buffer_load_dwordx4 v252, s[12:15], s46 offen offset:128 nt lds
    s_add_u32 m0, s47, 1792
    s_nop 0
    buffer_load_dwordx4 v252, s[12:15], s46 offen offset:256 nt lds
    s_add_u32 s46, s26, 0
    s_add_u32 s47, s26, 49152
    s_add_u32 m0, s47, 0
    s_nop 0
    buffer_load_dwordx4 v252, s[4:7], s46 offen offset:0 nt lds
    s_add_u32 m0, s47, 896
    s_nop 0
    buffer_load_dwordx4 v252, s[4:7], s46 offen offset:128 nt lds
    s_add_u32 m0, s47, 1792
    s_nop 0
    buffer_load_dwordx4 v252, s[4:7], s46 offen offset:256 nt lds
    s_add_u32 s46, s26, 12288
    s_add_u32 s47, s26, 61440
    s_add_u32 m0, s47, 0
    s_nop 0
    buffer_load_dwordx4 v252, s[4:7], s46 offen offset:0 nt lds
    s_add_u32 m0, s47, 896
    s_nop 0
    buffer_load_dwordx4 v252, s[4:7], s46 offen offset:128 nt lds
    s_add_u32 m0, s47, 1792
    s_nop 0
    buffer_load_dwordx4 v252, s[4:7], s46 offen offset:256 nt lds
    s_add_u32 s46, s26, 24576
    s_add_u32 s47, s26, 73728
    s_add_u32 m0, s47, 0
    s_nop 0
    buffer_load_dwordx4 v252, s[4:7], s46 offen offset:0 nt lds
    s_add_u32 m0, s47, 896
    s_nop 0
    buffer_load_dwordx4 v252, s[4:7], s46 offen offset:128 nt lds
    s_add_u32 m0, s47, 1792
    s_nop 0
    buffer_load_dwordx4 v252, s[4:7], s46 offen offset:256 nt lds
    s_add_u32 s46, s26, 36864
    s_add_u32 s47, s26, 86016
    s_add_u32 m0, s47, 0
    s_nop 0
    buffer_load_dwordx4 v252, s[4:7], s46 offen offset:0 nt lds
    s_add_u32 m0, s47, 896
    s_nop 0
    buffer_load_dwordx4 v252, s[4:7], s46 offen offset:128 nt lds
    s_add_u32 m0, s47, 1792
    s_nop 0
    buffer_load_dwordx4 v252, s[4:7], s46 offen offset:256 nt lds
    s_add_u32 s46, s26, 49152
    s_add_u32 s47, s26, 98304
    s_add_u32 m0, s47, 0
    s_nop 0
    buffer_load_dwordx4 v252, s[4:7], s46 offen offset:0 nt lds
    s_add_u32 m0, s47, 896
    s_nop 0
    buffer_load_dwordx4 v252, s[4:7], s46 offen offset:128 nt lds
    s_add_u32 m0, s47, 1792
    s_nop 0
    buffer_load_dwordx4 v252, s[4:7], s46 offen offset:256 nt lds
    s_add_u32 s46, s26, 61440
    s_add_u32 s47, s26, 110592
    s_add_u32 m0, s47, 0
    s_nop 0
    buffer_load_dwordx4 v252, s[4:7], s46 offen offset:0 nt lds
    s_add_u32 m0, s47, 896
    s_nop 0
    buffer_load_dwordx4 v252, s[4:7], s46 offen offset:128 nt lds
    s_add_u32 m0, s47, 1792
    s_nop 0
    buffer_load_dwordx4 v252, s[4:7], s46 offen offset:256 nt lds
    s_add_u32 s46, s26, 0
    s_add_u32 s47, s26, 12288
    s_add_u32 m0, s47, 0
    s_nop 0
    buffer_load_dwordx4 v252, s[20:23], s46 offen offset:0 nt lds
    s_add_u32 m0, s47, 896
    s_nop 0
    buffer_load_dwordx4 v252, s[20:23], s46 offen offset:128 nt lds
    s_add_u32 m0, s47, 1792
    s_nop 0
    buffer_load_dwordx4 v252, s[20:23], s46 offen offset:256 nt lds
    s_add_u32 s46, s26, 12288
    s_add_u32 s47, s26, 24576
    s_add_u32 m0, s47, 0
    s_nop 0
    buffer_load_dwordx4 v252, s[12:15], s46 offen offset:0 nt lds
    s_add_u32 m0, s47, 896
    s_nop 0
    buffer_load_dwordx4 v252, s[12:15], s46 offen offset:128 nt lds
    s_add_u32 m0, s47, 1792
    s_nop 0
    buffer_load_dwordx4 v252, s[12:15], s46 offen offset:256 nt lds
    s_add_u32 s46, s26, 12288
    s_add_u32 s47, s26, 36864
    s_add_u32 m0, s47, 0
    s_nop 0
    buffer_load_dwordx4 v252, s[20:23], s46 offen offset:0 nt lds
    s_add_u32 m0, s47, 896
    s_nop 0
    buffer_load_dwordx4 v252, s[20:23], s46 offen offset:128 nt lds
    s_add_u32 m0, s47, 1792
    s_nop 0
    buffer_load_dwordx4 v252, s[20:23], s46 offen offset:256 nt lds
    v_mov_b32 v244, 0xf149f2ca
    v_mov_b32 v247, 0
    v_mov_b32 v245, 0xf149f2ca
    v_mov_b32 v248, 0
    v_mov_b32 v246, 0xf149f2ca
    v_mov_b32 v249, 0
    s_cmp_eq_u32 s24, 7
    s_cbranch_scc0 L_pad1
    v_mov_b32 v246, 0x7149f2ca
L_pad1:
    s_waitcnt vmcnt(6)
    s_barrier
    s_cmp_ge_u32 s24, 4
    s_cbranch_scc1 L_qr2
    s_mul_i32 s46, s24, 3
    s_mul_i32 s35, s46, 6144
    s_add_u32 s35, s35, 49152
    v_add_u32 v254, s35, v250
    v_xor_b32 v255, 64, v254
    ds_read_b128 v[144:147], v254 offset:0
    ds_read_b128 v[148:151], v255 offset:0
    ds_read_b128 v[152:155], v254 offset:1024
    ds_read_b128 v[156:159], v255 offset:1024
    ds_read_b128 v[160:163], v254 offset:2048
    ds_read_b128 v[164:167], v255 offset:2048
    s_waitcnt lgkmcnt(6)
L_qr2:
    s_cmp_ge_u32 s24, 4
    s_cbranch_scc1 L_qr3
    s_mul_i32 s46, s24, 3
    s_add_u32 s46, s46, 1
    s_mul_i32 s35, s46, 6144
    s_add_u32 s35, s35, 49152
    v_add_u32 v254, s35, v250
    v_xor_b32 v255, 64, v254
    ds_read_b128 v[168:171], v254 offset:0
    ds_read_b128 v[172:175], v255 offset:0
    ds_read_b128 v[176:179], v254 offset:1024
    ds_read_b128 v[180:183], v255 offset:1024
    ds_read_b128 v[184:187], v254 offset:2048
    ds_read_b128 v[188:191], v255 offset:2048
    s_waitcnt lgkmcnt(6)
L_qr3:
    s_cmp_ge_u32 s24, 4
    s_cbranch_scc1 L_qr4
    s_mul_i32 s46, s24, 3
    s_add_u32 s46, s46, 2
    s_mul_i32 s35, s46, 6144
    s_add_u32 s35, s35, 49152
    v_add_u32 v254, s35, v250
    v_xor_b32 v255, 64, v254
    ds_read_b128 v[192:195], v254 offset:0
    ds_read_b128 v[196:199], v255 offset:0
    ds_read_b128 v[200:203], v254 offset:1024
    ds_read_b128 v[204:207], v255 offset:1024
    ds_read_b128 v[232:235], v254 offset:2048
    ds_read_b128 v[236:239], v255 offset:2048
    s_waitcnt lgkmcnt(0)
    ds_write_b128 v253, v[232:235] offset:0
    ds_write_b128 v253, v[236:239] offset:1024
L_qr4:
    s_waitcnt lgkmcnt(0)
    s_barrier
    s_branch L_pro_a
L_pro_gb:
    s_add_u32 s46, s26, 73728
    s_add_u32 s47, s26, 122880
    s_add_u32 m0, s47, 0
    s_nop 0
    buffer_load_dwordx4 v252, s[4:7], s46 offen offset:0 nt lds
    s_add_u32 m0, s47, 896
    s_nop 0
    buffer_load_dwordx4 v252, s[4:7], s46 offen offset:128 nt lds
    s_add_u32 m0, s47, 1792
    s_nop 0
    buffer_load_dwordx4 v252, s[4:7], s46 offen offset:256 nt lds
    s_add_u32 s46, s26, 86016
    s_add_u32 s47, s26, 135168
    s_add_u32 m0, s47, 0
    s_nop 0
    buffer_load_dwordx4 v252, s[4:7], s46 offen offset:0 nt lds
    s_add_u32 m0, s47, 896
    s_nop 0
    buffer_load_dwordx4 v252, s[4:7], s46 offen offset:128 nt lds
    s_add_u32 m0, s47, 1792
    s_nop 0
    buffer_load_dwordx4 v252, s[4:7], s46 offen offset:256 nt lds
    s_barrier
    s_barrier
    s_add_u32 s46, s26, 98304
    s_add_u32 s47, s26, 98304
    s_add_u32 m0, s47, 0
    s_nop 0
    buffer_load_dwordx4 v252, s[4:7], s46 offen offset:0 nt lds
    s_add_u32 m0, s47, 896
    s_nop 0
    buffer_load_dwordx4 v252, s[4:7], s46 offen offset:128 nt lds
    s_add_u32 m0, s47, 1792
    s_nop 0
    buffer_load_dwordx4 v252, s[4:7], s46 offen offset:256 nt lds
    s_add_u32 s46, s26, 110592
    s_add_u32 s47, s26, 110592
    s_add_u32 m0, s47, 0
    s_nop 0
    buffer_load_dwordx4 v252, s[4:7], s46 offen offset:0 nt lds
    s_add_u32 m0, s47, 896
    s_nop 0
    buffer_load_dwordx4 v252, s[4:7], s46 offen offset:128 nt lds
    s_add_u32 m0, s47, 1792
    s_nop 0
    buffer_load_dwordx4 v252, s[4:7], s46 offen offset:256 nt lds
    s_add_u32 s46, s26, 24576
    s_add_u32 s47, s26, 49152
    s_add_u32 m0, s47, 0
    s_nop 0
    buffer_load_dwordx4 v252, s[12:15], s46 offen offset:0 nt lds
    s_add_u32 m0, s47, 896
    s_nop 0
    buffer_load_dwordx4 v252, s[12:15], s46 offen offset:128 nt lds
    s_add_u32 m0, s47, 1792
    s_nop 0
    buffer_load_dwordx4 v252, s[12:15], s46 offen offset:256 nt lds
    v_mov_b32 v244, 0xf149f2ca
    v_mov_b32 v247, 0
    v_mov_b32 v245, 0xf149f2ca
    v_mov_b32 v248, 0
    v_mov_b32 v246, 0xf149f2ca
    v_mov_b32 v249, 0
    s_cmp_eq_u32 s24, 7
    s_cbranch_scc0 L_pad5
    v_mov_b32 v246, 0x7149f2ca
L_pad5:
    s_waitcnt vmcnt(9)
    s_barrier
    s_cmp_ge_u32 s24, 6
    s_cbranch_scc1 L_qr6
    s_cmp_lt_u32 s24, 4
    s_cbranch_scc1 L_qr6
    s_mul_i32 s46, s24, 3
    s_mul_i32 s35, s46, 6144
    s_add_u32 s35, s35, 49152
    v_add_u32 v254, s35, v250
    v_xor_b32 v255, 64, v254
    ds_read_b128 v[144:147], v254 offset:0
    ds_read_b128 v[148:151], v255 offset:0
    ds_read_b128 v[152:155], v254 offset:1024
    ds_read_b128 v[156:159], v255 offset:1024
    ds_read_b128 v[160:163], v254 offset:2048
    ds_read_b128 v[164:167], v255 offset:2048
    s_waitcnt lgkmcnt(6)
L_qr6:
    s_cmp_ge_u32 s24, 5
    s_cbranch_scc1 L_qr7
    s_cmp_lt_u32 s24, 4
    s_cbranch_scc1 L_qr7
    s_mul_i32 s46, s24, 3
    s_add_u32 s46, s46, 1
    s_mul_i32 s35, s46, 6144
    s_add_u32 s35, s35, 49152
    v_add_u32 v254, s35, v250
    v_xor_b32 v255, 64, v254
    ds_read_b128 v[168:171], v254 offset:0
    ds_read_b128 v[172:175], v255 offset:0
    ds_read_b128 v[176:179], v254 offset:1024
    ds_read_b128 v[180:183], v255 offset:1024
    ds_read_b128 v[184:187], v254 offset:2048
    ds_read_b128 v[188:191], v255 offset:2048
    s_waitcnt lgkmcnt(6)
L_qr7:
    s_cmp_ge_u32 s24, 5
    s_cbranch_scc1 L_qr8
    s_cmp_lt_u32 s24, 4
    s_cbranch_scc1 L_qr8
    s_mul_i32 s46, s24, 3
    s_add_u32 s46, s46, 2
    s_mul_i32 s35, s46, 6144
    s_add_u32 s35, s35, 49152
    v_add_u32 v254, s35, v250
    v_xor_b32 v255, 64, v254
    ds_read_b128 v[192:195], v254 offset:0
    ds_read_b128 v[196:199], v255 offset:0
    ds_read_b128 v[200:203], v254 offset:1024
    ds_read_b128 v[204:207], v255 offset:1024
    ds_read_b128 v[232:235], v254 offset:2048
    ds_read_b128 v[236:239], v255 offset:2048
    s_waitcnt lgkmcnt(0)
    ds_write_b128 v253, v[232:235] offset:0
    ds_write_b128 v253, v[236:239] offset:1024
L_qr8:
    s_waitcnt lgkmcnt(0)
    s_add_u32 s46, s26, 24576
    s_add_u32 s47, s26, 61440
    s_add_u32 m0, s47, 0
    s_nop 0
    buffer_load_dwordx4 v252, s[20:23], s46 offen offset:0 nt lds
    s_add_u32 m0, s47, 896
    s_nop 0
    buffer_load_dwordx4 v252, s[20:23], s46 offen offset:128 nt lds
    s_add_u32 m0, s47, 1792
    s_nop 0
    buffer_load_dwordx4 v252, s[20:23], s46 offen offset:256 nt lds
    s_add_u32 s46, s26, 36864
    s_add_u32 s47, s26, 73728
    s_add_u32 m0, s47, 0
    s_nop 0
    buffer_load_dwordx4 v252, s[12:15], s46 offen offset:0 nt lds
    s_add_u32 m0, s47, 896
    s_nop 0
    buffer_load_dwordx4 v252, s[12:15], s46 offen offset:128 nt lds
    s_add_u32 m0, s47, 1792
    s_nop 0
    buffer_load_dwordx4 v252, s[12:15], s46 offen offset:256 nt lds
    s_barrier
    s_add_u32 s46, s26, 122880
    s_add_u32 s47, s26, 122880
    s_add_u32 m0, s47, 0
    s_nop 0
    buffer_load_dwordx4 v252, s[4:7], s46 offen offset:0 nt lds
    s_add_u32 m0, s47, 896
    s_nop 0
    buffer_load_dwordx4 v252, s[4:7], s46 offen offset:128 nt lds
    s_add_u32 m0, s47, 1792
    s_nop 0
    buffer_load_dwordx4 v252, s[4:7], s46 offen offset:256 nt lds
    s_add_u32 s46, s26, 135168
    s_add_u32 s47, s26, 135168
    s_add_u32 m0, s47, 0
    s_nop 0
    buffer_load_dwordx4 v252, s[4:7], s46 offen offset:0 nt lds
    s_add_u32 m0, s47, 896
    s_nop 0
    buffer_load_dwordx4 v252, s[4:7], s46 offen offset:128 nt lds
    s_add_u32 m0, s47, 1792
    s_nop 0
    buffer_load_dwordx4 v252, s[4:7], s46 offen offset:256 nt lds
    s_waitcnt vmcnt(12)
    s_barrier
    s_cmp_ge_u32 s24, 7
    s_cbranch_scc1 L_qr9
    s_cmp_lt_u32 s24, 6
    s_cbranch_scc1 L_qr9
    s_mul_i32 s46, s24, 3
    s_mul_i32 s35, s46, 6144
    s_add_u32 s35, s35, 0
    v_add_u32 v254, s35, v250
    v_xor_b32 v255, 64, v254
    ds_read_b128 v[144:147], v254 offset:0
    ds_read_b128 v[148:151], v255 offset:0
    ds_read_b128 v[152:155], v254 offset:1024
    ds_read_b128 v[156:159], v255 offset:1024
    ds_read_b128 v[160:163], v254 offset:2048
    ds_read_b128 v[164:167], v255 offset:2048
    s_waitcnt lgkmcnt(6)
L_qr9:
    s_cmp_ge_u32 s24, 7
    s_cbranch_scc1 L_qr10
    s_cmp_lt_u32 s24, 5
    s_cbranch_scc1 L_qr10
    s_mul_i32 s46, s24, 3
    s_add_u32 s46, s46, 1
    s_mul_i32 s35, s46, 6144
    s_add_u32 s35, s35, 0
    v_add_u32 v254, s35, v250
    v_xor_b32 v255, 64, v254
    ds_read_b128 v[168:171], v254 offset:0
    ds_read_b128 v[172:175], v255 offset:0
    ds_read_b128 v[176:179], v254 offset:1024
    ds_read_b128 v[180:183], v255 offset:1024
    ds_read_b128 v[184:187], v254 offset:2048
    ds_read_b128 v[188:191], v255 offset:2048
    s_waitcnt lgkmcnt(6)
L_qr10:
    s_cmp_ge_u32 s24, 6
    s_cbranch_scc1 L_qr11
    s_cmp_lt_u32 s24, 5
    s_cbranch_scc1 L_qr11
    s_mul_i32 s46, s24, 3
    s_add_u32 s46, s46, 2
    s_mul_i32 s35, s46, 6144
    s_add_u32 s35, s35, 0
    v_add_u32 v254, s35, v250
    v_xor_b32 v255, 64, v254
    ds_read_b128 v[192:195], v254 offset:0
    ds_read_b128 v[196:199], v255 offset:0
    ds_read_b128 v[200:203], v254 offset:1024
    ds_read_b128 v[204:207], v255 offset:1024
    ds_read_b128 v[232:235], v254 offset:2048
    ds_read_b128 v[236:239], v255 offset:2048
    s_waitcnt lgkmcnt(0)
    ds_write_b128 v253, v[232:235] offset:0
    ds_write_b128 v253, v[236:239] offset:1024
L_qr11:
    s_waitcnt lgkmcnt(0)
    s_waitcnt vmcnt(9)
    s_barrier
    s_add_u32 s46, s26, 49152
    s_add_u32 s47, s26, 98304
    s_add_u32 m0, s47, 0
    s_nop 0
    buffer_load_dwordx4 v252, s[12:15], s46 offen offset:0 nt lds
    s_add_u32 m0, s47, 896
    s_nop 0
    buffer_load_dwordx4 v252, s[12:15], s46 offen offset:128 nt lds
    s_add_u32 m0, s47, 1792
    s_nop 0
    buffer_load_dwordx4 v252, s[12:15], s46 offen offset:256 nt lds
    s_waitcnt vmcnt(3)
    s_barrier
    s_cmp_ge_u32 s24, 8
    s_cbranch_scc1 L_qr12
    s_cmp_lt_u32 s24, 7
    s_cbranch_scc1 L_qr12
    s_mul_i32 s46, s24, 3
    s_mul_i32 s35, s46, 6144
    s_add_u32 s35, s35, 0
    v_add_u32 v254, s35, v250
    v_xor_b32 v255, 64, v254
    ds_read_b128 v[144:147], v254 offset:0
    ds_read_b128 v[148:151], v255 offset:0
    ds_read_b128 v[152:155], v254 offset:1024
    ds_read_b128 v[156:159], v255 offset:1024
    ds_read_b128 v[160:163], v254 offset:2048
    ds_read_b128 v[164:167], v255 offset:2048
    s_waitcnt lgkmcnt(6)
L_qr12:
    s_cmp_ge_u32 s24, 8
    s_cbranch_scc1 L_qr13
    s_cmp_lt_u32 s24, 7
    s_cbranch_scc1 L_qr13
    s_mul_i32 s46, s24, 3
    s_add_u32 s46, s46, 1
    s_mul_i32 s35, s46, 6144
    s_add_u32 s35, s35, 0
    v_add_u32 v254, s35, v250
    v_xor_b32 v255, 64, v254
    ds_read_b128 v[168:171], v254 offset:0
    ds_read_b128 v[172:175], v255 offset:0
    ds_read_b128 v[176:179], v254 offset:1024
    ds_read_b128 v[180:183], v255 offset:1024
    ds_read_b128 v[184:187], v254 offset:2048
    ds_read_b128 v[188:191], v255 offset:2048
    s_waitcnt lgkmcnt(6)
L_qr13:
    s_cmp_ge_u32 s24, 8
    s_cbranch_scc1 L_qr14
    s_cmp_lt_u32 s24, 6
    s_cbranch_scc1 L_qr14
    s_mul_i32 s46, s24, 3
    s_add_u32 s46, s46, 2
    s_mul_i32 s35, s46, 6144
    s_add_u32 s35, s35, 0
    v_add_u32 v254, s35, v250
    v_xor_b32 v255, 64, v254
    ds_read_b128 v[192:195], v254 offset:0
    ds_read_b128 v[196:199], v255 offset:0
    ds_read_b128 v[200:203], v254 offset:1024
    ds_read_b128 v[204:207], v255 offset:1024
    ds_read_b128 v[232:235], v254 offset:2048
    ds_read_b128 v[236:239], v255 offset:2048
    s_waitcnt lgkmcnt(0)
    ds_write_b128 v253, v[232:235] offset:0
    ds_write_b128 v253, v[236:239] offset:1024
L_qr14:
    s_waitcnt lgkmcnt(0)
L_pro_a:
    s_mov_b32 s29, 0
    s_mov_b32 s32, 0
    s_mul_i32 s30, s25, 3
    s_add_u32 s30, s30, 3
    s_mul_i32 s30, s30, 12288
    s_add_u32 s30, s30, s26
    s_cmp_eq_u32 s25, 0
    s_cselect_b32 s31, 73728, 0
    s_setprio 2
    s_branch L_slow
.p2align 6
L_loop:
    s_setprio 1
    s_waitcnt lgkmcnt(10)
    v_mfma_f32_16x16x32_bf16 v[0:3], v[232:235], v[208:211], v[0:3]
    v_xor_b32 v251, 96, v251
    v_mfma_f32_16x16x32_bf16 v[48:51], v[232:235], v[212:215], v[48:51]
    v_mfma_f32_16x16x32_bf16 v[96:99], v[232:235], v[216:219], v[96:99]
    s_waitcnt lgkmcnt(8)
    v_mfma_f32_16x16x32_bf16 v[16:19], v[236:239], v[208:211], v[16:19]
    ds_read_b64_tr_b16 v[232:233], v251 offset:0
    v_mfma_f32_16x16x32_bf16 v[64:67], v[236:239], v[212:215], v[64:67]
    ds_read_b64_tr_b16 v[234:235], v251 offset:6144
    v_mfma_f32_16x16x32_bf16 v[112:115], v[236:239], v[216:219], v[112:115]
    s_waitcnt lgkmcnt(8)
    v_mfma_f32_16x16x32_bf16 v[32:35], v[240:243], v[208:211], v[32:35]
    ds_read_b64_tr_b16 v[236:237], v251 offset:1024
    v_mfma_f32_16x16x32_bf16 v[80:83], v[240:243], v[212:215], v[80:83]
    ds_read_b64_tr_b16 v[238:239], v251 offset:7168
    v_mfma_f32_16x16x32_bf16 v[128:131], v[240:243], v[216:219], v[128:131]
    s_waitcnt lgkmcnt(8)
    v_mfma_f32_16x16x32_bf16 v[4:7], v[220:223], v[208:211], v[4:7]
    ds_read_b64_tr_b16 v[240:241], v251 offset:2048
    v_mfma_f32_16x16x32_bf16 v[52:55], v[220:223], v[212:215], v[52:55]
    ds_read_b64_tr_b16 v[242:243], v251 offset:8192
    v_mfma_f32_16x16x32_bf16 v[100:103], v[220:223], v[216:219], v[100:103]
    v_xor_b32 v251, 32, v251
    s_waitcnt lgkmcnt(8)
    v_mfma_f32_16x16x32_bf16 v[20:23], v[224:227], v[208:211], v[20:23]
    ds_read_b64_tr_b16 v[220:221], v251 offset:0
    v_mfma_f32_16x16x32_bf16 v[68:71], v[224:227], v[212:215], v[68:71]
    ds_read_b64_tr_b16 v[222:223], v251 offset:6144
    v_mfma_f32_16x16x32_bf16 v[116:119], v[224:227], v[216:219], v[116:119]
    s_waitcnt lgkmcnt(8)
    v_mfma_f32_16x16x32_bf16 v[36:39], v[228:231], v[208:211], v[36:39]
    ds_read_b64_tr_b16 v[224:225], v251 offset:1024
    v_mfma_f32_16x16x32_bf16 v[84:87], v[228:231], v[212:215], v[84:87]
    ds_read_b64_tr_b16 v[226:227], v251 offset:7168
    v_mfma_f32_16x16x32_bf16 v[132:135], v[228:231], v[216:219], v[132:135]
    s_waitcnt lgkmcnt(8)
    v_mfma_f32_16x16x32_bf16 v[8:11], v[232:235], v[208:211], v[8:11]
    ds_read_b64_tr_b16 v[228:229], v251 offset:2048
    v_mfma_f32_16x16x32_bf16 v[56:59], v[232:235], v[212:215], v[56:59]
    ds_read_b64_tr_b16 v[230:231], v251 offset:8192
    v_mfma_f32_16x16x32_bf16 v[104:107], v[232:235], v[216:219], v[104:107]
    s_waitcnt lgkmcnt(8)
    v_mfma_f32_16x16x32_bf16 v[24:27], v[236:239], v[208:211], v[24:27]
    ds_read_b128 v[232:235], v250 offset:0
    v_mfma_f32_16x16x32_bf16 v[72:75], v[236:239], v[212:215], v[72:75]
    v_xor_b32 v251, 96, v251
    v_mfma_f32_16x16x32_bf16 v[120:123], v[236:239], v[216:219], v[120:123]
    v_add_u32 v251, s34, v251
    s_waitcnt lgkmcnt(7)
    v_mfma_f32_16x16x32_bf16 v[40:43], v[240:243], v[208:211], v[40:43]
    ds_read_b128 v[236:239], v250 offset:1024
    v_mfma_f32_16x16x32_bf16 v[88:91], v[240:243], v[212:215], v[88:91]
    s_add_u32 s29, s29, 1
    v_mfma_f32_16x16x32_bf16 v[136:139], v[240:243], v[216:219], v[136:139]
    s_and_b32 s46, s29, 15
    s_waitcnt lgkmcnt(6)
    v_mfma_f32_16x16x32_bf16 v[12:15], v[220:223], v[208:211], v[12:15]
    ds_read_b128 v[240:243], v250 offset:2048
    v_mfma_f32_16x16x32_bf16 v[60:63], v[220:223], v[212:215], v[60:63]
    v_xor_b32 v250, 64, v250
    v_mfma_f32_16x16x32_bf16 v[108:111], v[220:223], v[216:219], v[108:111]
    s_cmp_eq_u32 s46, 0
    s_cbranch_scc1 L_exit
    s_waitcnt lgkmcnt(5)
    v_mfma_f32_16x16x32_bf16 v[28:31], v[224:227], v[208:211], v[28:31]
    ds_read_b128 v[220:223], v253 offset:0
    v_mfma_f32_16x16x32_bf16 v[76:79], v[224:227], v[212:215], v[76:79]
    s_sub_u32 s46, s29, 13
    v_mfma_f32_16x16x32_bf16 v[124:127], v[224:227], v[216:219], v[124:127]
    s_cmp_lt_u32 s46, 2
    s_cbranch_scc1 L_xw3
    s_waitcnt vmcnt(6)
L_xw:
    s_waitcnt lgkmcnt(4)
    s_barrier
    s_setprio 2
    v_mfma_f32_16x16x32_bf16 v[44:47], v[228:231], v[208:211], v[44:47]
    ds_read_b128 v[224:227], v250 offset:0
    v_mfma_f32_16x16x32_bf16 v[92:95], v[228:231], v[212:215], v[92:95]
    v_mfma_f32_16x16x32_bf16 v[140:143], v[228:231], v[216:219], v[140:143]
    ds_read_b128 v[228:231], v250 offset:1024
L_qk:
    s_waitcnt lgkmcnt(5)
    v_mfma_f32_16x16x32_bf16 v[208:211], v[232:235], v[144:147], 0
    s_add_u32 s33, s32, 24576
    s_cmp_eq_u32 s33, 147456
    v_mfma_f32_16x16x32_bf16 v[212:215], v[232:235], v[168:171], 0
    s_cselect_b32 s33, 0, s33
    s_sub_u32 s34, s33, s32
    v_mfma_f32_16x16x32_bf16 v[216:219], v[232:235], v[192:195], 0
    s_mov_b32 s32, s33
    s_waitcnt lgkmcnt(4)
    v_mfma_f32_16x16x32_bf16 v[208:211], v[236:239], v[152:155], v[208:211]
    ds_read_b128 v[232:235], v250 offset:2048
    v_mfma_f32_16x16x32_bf16 v[212:215], v[236:239], v[176:179], v[212:215]
    s_add_u32 s35, s31, s27
    s_add_u32 s50, s29, s42
    v_mfma_f32_16x16x32_bf16 v[216:219], v[236:239], v[200:203], v[216:219]
    s_mul_i32 s33, s50, 24576
    s_waitcnt lgkmcnt(3)
    v_mfma_f32_16x16x32_bf16 v[208:211], v[240:243], v[160:163], v[208:211]
    ds_read_b128 v[236:239], v253 offset:1024
    v_mfma_f32_16x16x32_bf16 v[212:215], v[240:243], v[184:187], v[212:215]
    s_add_u32 s33, s33, s44
    s_cmp_lt_u32 s50, s43
    v_mfma_f32_16x16x32_bf16 v[216:219], v[240:243], v[220:223], v[216:219]
    s_cselect_b32 s45, s33, s30
    s_waitcnt lgkmcnt(3)
    v_mfma_f32_16x16x32_bf16 v[208:211], v[224:227], v[148:151], v[208:211]
    ds_read_b128 v[240:243], v250 offset:8192
    v_mfma_f32_16x16x32_bf16 v[212:215], v[224:227], v[172:175], v[212:215]
    s_cselect_b32 s8, s40, s38
    s_cselect_b32 s9, s41, s39
    v_mfma_f32_16x16x32_bf16 v[216:219], v[224:227], v[196:199], v[216:219]
    s_cselect_b32 s10, s3, s100
    s_waitcnt lgkmcnt(1)
    v_mfma_f32_16x16x32_bf16 v[208:211], v[232:235], v[164:167], v[208:211]
    s_add_u32 s30, s30, 12288
    s_add_u32 s31, s31, 24576
    v_mfma_f32_16x16x32_bf16 v[212:215], v[232:235], v[188:191], v[212:215]
    s_cmp_eq_u32 s31, 147456
    s_cselect_b32 s31, 0, s31
    v_mfma_f32_16x16x32_bf16 v[216:219], v[232:235], v[236:239], v[216:219]
    v_mfma_f32_16x16x32_bf16 v[208:211], v[228:231], v[156:159], v[208:211]
    ds_read_b128 v[232:235], v250 offset:6144
    v_mfma_f32_16x16x32_bf16 v[212:215], v[228:231], v[180:183], v[212:215]
    v_mfma_f32_16x16x32_bf16 v[216:219], v[228:231], v[204:207], v[216:219]
    s_waitcnt lgkmcnt(1)
    v_mfma_f32_16x16x32_bf16 v[220:223], v[240:243], v[164:167], 0
    v_mfma_f32_16x16x32_bf16 v[224:227], v[240:243], v[188:191], 0
    v_mfma_f32_16x16x32_bf16 v[228:231], v[240:243], v[236:239], 0
    ds_read_b128 v[240:243], v250 offset:7168
    s_waitcnt lgkmcnt(1)
    v_mfma_f32_16x16x32_bf16 v[220:223], v[232:235], v[148:151], v[220:223]
    v_xor_b32 v250, 64, v250
    v_fma_f32 v208, v208, s28, -v244
    v_mfma_f32_16x16x32_bf16 v[224:227], v[232:235], v[172:175], v[224:227]
    ds_read_b128 v[236:239], v250 offset:6144
    v_fma_f32 v209, v209, s28, -v244
    v_fma_f32 v210, v210, s28, -v244
    v_mfma_f32_16x16x32_bf16 v[228:231], v[232:235], v[196:199], v[228:231]
    v_fma_f32 v211, v211, s28, -v244
    s_waitcnt lgkmcnt(1)
    v_mfma_f32_16x16x32_bf16 v[220:223], v[240:243], v[156:159], v[220:223]
    ds_read_b128 v[232:235], v250 offset:7168
    v_exp_f32 v208, v208
    v_mfma_f32_16x16x32_bf16 v[224:227], v[240:243], v[180:183], v[224:227]
    v_exp_f32 v209, v209
    v_mfma_f32_16x16x32_bf16 v[228:231], v[240:243], v[204:207], v[228:231]
    v_fma_f32 v212, v212, s28, -v245
    s_waitcnt lgkmcnt(1)
    v_mfma_f32_16x16x32_bf16 v[220:223], v[236:239], v[144:147], v[220:223]
    ds_read_b128 v[240:243], v250 offset:8192
    v_fma_f32 v213, v213, s28, -v245
    v_mfma_f32_16x16x32_bf16 v[224:227], v[236:239], v[168:171], v[224:227]
    v_exp_f32 v210, v210
    v_mfma_f32_16x16x32_bf16 v[228:231], v[236:239], v[192:195], v[228:231]
    s_waitcnt lgkmcnt(1)
    v_mfma_f32_16x16x32_bf16 v[220:223], v[232:235], v[152:155], v[220:223]
    ds_read_b128 v[236:239], v253 offset:0
    v_exp_f32 v211, v211
    v_mfma_f32_16x16x32_bf16 v[224:227], v[232:235], v[176:179], v[224:227]
    v_fma_f32 v214, v214, s28, -v245
    v_fma_f32 v215, v215, s28, -v245
    v_mfma_f32_16x16x32_bf16 v[228:231], v[232:235], v[200:203], v[228:231]
    s_waitcnt lgkmcnt(0)
    v_mfma_f32_16x16x32_bf16 v[220:223], v[240:243], v[160:163], v[220:223]
    ds_read_b64_tr_b16 v[232:233], v251 offset:0
    v_mfma_f32_16x16x32_bf16 v[224:227], v[240:243], v[184:187], v[224:227]
    ds_read_b64_tr_b16 v[234:235], v251 offset:6144
    v_mfma_f32_16x16x32_bf16 v[228:231], v[240:243], v[236:239], v[228:231]
    ds_read_b64_tr_b16 v[236:237], v251 offset:1024
    ds_read_b64_tr_b16 v[238:239], v251 offset:7168
    ds_read_b64_tr_b16 v[240:241], v251 offset:2048
    ds_read_b64_tr_b16 v[242:243], v251 offset:8192
    s_setprio 0
    v_exp_f32 v212, v212
    v_add_f32 v254, v208, v209
    v_cvt_pk_bf16_f32 v208, v208, v209
    v_exp_f32 v213, v213
    v_fma_f32 v216, v216, s28, -v246
    v_fma_f32 v217, v217, s28, -v246
    v_cvt_pk_bf16_f32 v209, v210, v211
    v_add_f32 v210, v210, v211
    v_exp_f32 v214, v214
    v_add_f32 v210, v210, v254
    v_exp_f32 v215, v215
    v_fma_f32 v218, v218, s28, -v246
    v_fma_f32 v219, v219, s28, -v246
    v_exp_f32 v216, v216
    v_add_f32 v255, v212, v213
    v_cvt_pk_bf16_f32 v212, v212, v213
    v_exp_f32 v217, v217
    v_cvt_pk_bf16_f32 v213, v214, v215
    v_add_f32 v214, v214, v215
    v_exp_f32 v218, v218
    v_add_f32 v214, v214, v255
    v_exp_f32 v219, v219
    v_add_f32 v254, v216, v217
    v_cvt_pk_bf16_f32 v216, v216, v217
    v_cvt_pk_bf16_f32 v217, v218, v219
    v_add_f32 v218, v218, v219
    v_add_f32 v218, v218, v254
    v_fma_f32 v220, v220, s28, -v244
    v_fma_f32 v221, v221, s28, -v244
    v_fma_f32 v222, v222, s28, -v244
    v_fma_f32 v223, v223, s28, -v244
    v_exp_f32 v220, v220
    v_exp_f32 v221, v221
    v_exp_f32 v222, v222
    v_exp_f32 v223, v223
    v_add_f32 v254, v220, v221
    v_add_f32 v255, v222, v223
    v_add_f32 v210, v210, v254
    v_add_f32 v210, v210, v255
    v_fma_f32 v224, v224, s28, -v245
    v_fma_f32 v225, v225, s28, -v245
    v_fma_f32 v226, v226, s28, -v245
    v_fma_f32 v227, v227, s28, -v245
    v_exp_f32 v224, v224
    v_exp_f32 v225, v225
    v_exp_f32 v226, v226
    v_exp_f32 v227, v227
    v_add_f32 v254, v224, v225
    v_add_f32 v255, v226, v227
    v_add_f32 v214, v214, v254
    v_add_f32 v214, v214, v255
    v_fma_f32 v228, v228, s28, -v246
    v_fma_f32 v229, v229, s28, -v246
    v_fma_f32 v230, v230, s28, -v246
    v_fma_f32 v231, v231, s28, -v246
L_pvb:
    s_and_b32 s46, s29, 14
    s_cmp_eq_u32 s46, 0
    s_cbranch_scc1 L_pw0
L_pv:
    s_barrier
    s_bitcmp1_b32 s51, s29
    s_cbranch_scc1 L_pv_spec
L_pv_reg:
    s_add_u32 m0, s35, 0
    s_nop 0
    buffer_load_dwordx4 v252, s[8:11], s45 offen offset:0 nt lds
    s_add_u32 m0, s35, 896
    s_nop 0
    buffer_load_dwordx4 v252, s[8:11], s45 offen offset:128 nt lds
    s_add_u32 m0, s35, 1792
    s_nop 0
    buffer_load_dwordx4 v252, s[8:11], s45 offen offset:256 nt lds
L_pv_done:
    s_and_b32 s46, s29, 15
    s_cmp_eq_u32 s46, 0
    s_cbranch_scc1 L_after
    v_exp_f32 v228, v228
    v_exp_f32 v229, v229
    v_exp_f32 v230, v230
    v_exp_f32 v231, v231
    v_add_f32 v254, v228, v229
    v_add_f32 v255, v230, v231
    v_add_f32 v218, v218, v254
    v_add_f32 v218, v218, v255
    v_max3_f32 v254, v210, v214, v218
    v_cmp_lt_f32 vcc, 0x44800000, v254
    s_nop 1
    s_cbranch_vccnz L_rare
L_after:
    v_add_f32 v247, v247, v210
    v_add_f32 v248, v248, v214
    v_add_f32 v249, v249, v218
    v_cvt_pk_bf16_f32 v210, v220, v221
    v_cvt_pk_bf16_f32 v211, v222, v223
    v_cvt_pk_bf16_f32 v214, v224, v225
    v_cvt_pk_bf16_f32 v215, v226, v227
    v_cvt_pk_bf16_f32 v218, v228, v229
    v_cvt_pk_bf16_f32 v219, v230, v231
    v_xor_b32 v251, 32, v251
    ds_read_b64_tr_b16 v[220:221], v251 offset:0
    ds_read_b64_tr_b16 v[222:223], v251 offset:6144
    ds_read_b64_tr_b16 v[224:225], v251 offset:1024
    ds_read_b64_tr_b16 v[226:227], v251 offset:7168
    ds_read_b64_tr_b16 v[228:229], v251 offset:2048
    ds_read_b64_tr_b16 v[230:231], v251 offset:8192
    v_add_u32 v250, s34, v250
    s_and_b32 s46, s29, 15
    s_cmp_lg_u32 s46, 0
    s_cbranch_scc1 L_loop
    s_setprio 1
    s_waitcnt lgkmcnt(10)
    v_mfma_f32_16x16x32_bf16 v[0:3], v[232:235], v[208:211], 0
    v_xor_b32 v251, 96, v251
    v_mfma_f32_16x16x32_bf16 v[48:51], v[232:235], v[212:215], 0
    v_mfma_f32_16x16x32_bf16 v[96:99], v[232:235], v[216:219], 0
    s_waitcnt lgkmcnt(8)
    v_mfma_f32_16x16x32_bf16 v[16:19], v[236:239], v[208:211], 0
    ds_read_b64_tr_b16 v[232:233], v251 offset:0
    v_mfma_f32_16x16x32_bf16 v[64:67], v[236:239], v[212:215], 0
    ds_read_b64_tr_b16 v[234:235], v251 offset:6144
    v_mfma_f32_16x16x32_bf16 v[112:115], v[236:239], v[216:219], 0
    s_waitcnt lgkmcnt(8)
    v_mfma_f32_16x16x32_bf16 v[32:35], v[240:243], v[208:211], 0
    ds_read_b64_tr_b16 v[236:237], v251 offset:1024
    v_mfma_f32_16x16x32_bf16 v[80:83], v[240:243], v[212:215], 0
    ds_read_b64_tr_b16 v[238:239], v251 offset:7168
    v_mfma_f32_16x16x32_bf16 v[128:131], v[240:243], v[216:219], 0
    s_waitcnt lgkmcnt(8)
    v_mfma_f32_16x16x32_bf16 v[4:7], v[220:223], v[208:211], 0
    ds_read_b64_tr_b16 v[240:241], v251 offset:2048
    v_mfma_f32_16x16x32_bf16 v[52:55], v[220:223], v[212:215], 0
    ds_read_b64_tr_b16 v[242:243], v251 offset:8192
    v_mfma_f32_16x16x32_bf16 v[100:103], v[220:223], v[216:219], 0
    v_xor_b32 v251, 32, v251
    s_waitcnt lgkmcnt(8)
    v_mfma_f32_16x16x32_bf16 v[20:23], v[224:227], v[208:211], 0
    ds_read_b64_tr_b16 v[220:221], v251 offset:0
    v_mfma_f32_16x16x32_bf16 v[68:71], v[224:227], v[212:215], 0
    ds_read_b64_tr_b16 v[222:223], v251 offset:6144
    v_mfma_f32_16x16x32_bf16 v[116:119], v[224:227], v[216:219], 0
    s_waitcnt lgkmcnt(8)
    v_mfma_f32_16x16x32_bf16 v[36:39], v[228:231], v[208:211], 0
    ds_read_b64_tr_b16 v[224:225], v251 offset:1024
    v_mfma_f32_16x16x32_bf16 v[84:87], v[228:231], v[212:215], 0
    ds_read_b64_tr_b16 v[226:227], v251 offset:7168
    v_mfma_f32_16x16x32_bf16 v[132:135], v[228:231], v[216:219], 0
    s_waitcnt lgkmcnt(8)
    v_mfma_f32_16x16x32_bf16 v[8:11], v[232:235], v[208:211], 0
    ds_read_b64_tr_b16 v[228:229], v251 offset:2048
    v_mfma_f32_16x16x32_bf16 v[56:59], v[232:235], v[212:215], 0
    ds_read_b64_tr_b16 v[230:231], v251 offset:8192
    v_mfma_f32_16x16x32_bf16 v[104:107], v[232:235], v[216:219], 0
    s_waitcnt lgkmcnt(8)
    v_mfma_f32_16x16x32_bf16 v[24:27], v[236:239], v[208:211], 0
    ds_read_b128 v[232:235], v250 offset:0
    v_mfma_f32_16x16x32_bf16 v[72:75], v[236:239], v[212:215], 0
    v_xor_b32 v251, 96, v251
    v_mfma_f32_16x16x32_bf16 v[120:123], v[236:239], v[216:219], 0
    v_add_u32 v251, s34, v251
    s_waitcnt lgkmcnt(7)
    v_mfma_f32_16x16x32_bf16 v[40:43], v[240:243], v[208:211], 0
    ds_read_b128 v[236:239], v250 offset:1024
    v_mfma_f32_16x16x32_bf16 v[88:91], v[240:243], v[212:215], 0
    s_add_u32 s29, s29, 1
    v_mfma_f32_16x16x32_bf16 v[136:139], v[240:243], v[216:219], 0
    s_and_b32 s46, s29, 15
    s_waitcnt lgkmcnt(6)
    v_mfma_f32_16x16x32_bf16 v[12:15], v[220:223], v[208:211], 0
    ds_read_b128 v[240:243], v250 offset:2048
    v_mfma_f32_16x16x32_bf16 v[60:63], v[220:223], v[212:215], 0
    v_xor_b32 v250, 64, v250
    v_mfma_f32_16x16x32_bf16 v[108:111], v[220:223], v[216:219], 0
    s_cmp_eq_u32 s46, 0
    s_waitcnt lgkmcnt(5)
    v_mfma_f32_16x16x32_bf16 v[28:31], v[224:227], v[208:211], 0
    ds_read_b128 v[220:223], v253 offset:0
    v_mfma_f32_16x16x32_bf16 v[76:79], v[224:227], v[212:215], 0
    s_sub_u32 s46, s29, 13
    v_mfma_f32_16x16x32_bf16 v[124:127], v[224:227], v[216:219], 0
    s_cmp_lt_u32 s46, 2
    s_waitcnt vmcnt(6)
    s_waitcnt lgkmcnt(4)
    s_barrier
    s_setprio 2
    v_mfma_f32_16x16x32_bf16 v[44:47], v[228:231], v[208:211], 0
    ds_read_b128 v[224:227], v250 offset:0
    v_mfma_f32_16x16x32_bf16 v[92:95], v[228:231], v[212:215], 0
    v_mfma_f32_16x16x32_bf16 v[140:143], v[228:231], v[216:219], 0
    ds_read_b128 v[228:231], v250 offset:1024
    s_branch L_qk
L_xw3:
    s_waitcnt vmcnt(3)
    s_branch L_xw
L_pw0:
    s_waitcnt vmcnt(0)
    s_branch L_pv
L_exit:
    s_waitcnt lgkmcnt(5)
    v_mfma_f32_16x16x32_bf16 v[28:31], v[224:227], v[208:211], v[28:31]
    v_mfma_f32_16x16x32_bf16 v[76:79], v[224:227], v[212:215], v[76:79]
    v_mfma_f32_16x16x32_bf16 v[124:127], v[224:227], v[216:219], v[124:127]
    s_waitcnt lgkmcnt(3)
    v_mfma_f32_16x16x32_bf16 v[44:47], v[228:231], v[208:211], v[44:47]
    v_mfma_f32_16x16x32_bf16 v[92:95], v[228:231], v[212:215], v[92:95]
    v_mfma_f32_16x16x32_bf16 v[140:143], v[228:231], v[216:219], v[140:143]
    s_waitcnt lgkmcnt(0)
    v_xor_b32 v250, 64, v250
    s_cmp_eq_u32 s29, 32
    s_cbranch_scc1 L_final
    s_setprio 0
    s_mov_b32 s4, s40
    s_mov_b32 s5, s41
    s_waitcnt vmcnt(3)
    s_barrier
    s_cmp_lg_u32 s25, 0
    s_cbranch_scc1 L_bnd_b
    v_mbcnt_lo_u32_b32 v216, -1, 0
    v_mbcnt_hi_u32_b32 v216, -1, v216
    v_and_b32 v215, 15, v216
    v_lshrrev_b32 v216, 4, v216
    v_lshrrev_b32 v213, 1, v216
    v_and_b32 v214, 7, v215
    v_xor_b32 v213, v213, v214
    v_lshlrev_b32 v213, 4, v213
    v_and_b32 v214, 1, v216
    v_lshl_add_u32 v213, v214, 3, v213
    v_lshl_add_u32 v213, v215, 7, v213
    v_add_u32 v208, s37, v213
    v_xor_b32 v209, 32, v208
    v_xor_b32 v210, 64, v208
    v_xor_b32 v211, 96, v208
    v_lshl_add_u32 v213, v216, 4, v215
    v_lshrrev_b32 v214, 3, v213
    v_xor_b32 v213, v213, v214
    v_and_b32 v213, 7, v213
    v_lshlrev_b32 v213, 4, v213
    v_add_u32 v214, s36, v214
    v_mul_u32_u24 v214, 384, v214
    v_add_u32 v212, v213, v214
    v_mov_b32 v254, v247
    s_nop 1
    v_permlane32_swap_b32 v247, v254
    v_add_f32 v247, v247, v254
    v_mov_b32 v254, v247
    s_nop 1
    v_permlane16_swap_b32 v247, v254
    v_add_f32 v247, v247, v254
    v_rcp_f32 v247, v247
    s_mov_b32 s46, 0
    s_mov_b32 s47, 3072
    v_mul_f32 v0, v0, v247
    v_mul_f32 v1, v1, v247
    v_mul_f32 v2, v2, v247
    v_mul_f32 v3, v3, v247
    v_cvt_pk_bf16_f32 v220, v0, v1
    v_cvt_pk_bf16_f32 v221, v2, v3
    v_mul_f32 v4, v4, v247
    v_mul_f32 v5, v5, v247
    v_mul_f32 v6, v6, v247
    v_mul_f32 v7, v7, v247
    v_cvt_pk_bf16_f32 v222, v4, v5
    v_cvt_pk_bf16_f32 v223, v6, v7
    v_mul_f32 v8, v8, v247
    v_mul_f32 v9, v9, v247
    v_mul_f32 v10, v10, v247
    v_mul_f32 v11, v11, v247
    v_cvt_pk_bf16_f32 v224, v8, v9
    v_cvt_pk_bf16_f32 v225, v10, v11
    v_mul_f32 v12, v12, v247
    v_mul_f32 v13, v13, v247
    v_mul_f32 v14, v14, v247
    v_mul_f32 v15, v15, v247
    v_cvt_pk_bf16_f32 v226, v12, v13
    v_cvt_pk_bf16_f32 v227, v14, v15
    ds_write_b64 v208, v[220:221]
    ds_write_b64 v209, v[222:223]
    ds_write_b64 v210, v[224:225]
    ds_write_b64 v211, v[226:227]
    ds_read_b128 v[232:235], v253 offset:0
    ds_read_b128 v[236:239], v253 offset:1024
    v_mul_f32 v16, v16, v247
    v_mul_f32 v17, v17, v247
    v_mul_f32 v18, v18, v247
    v_mul_f32 v19, v19, v247
    v_cvt_pk_bf16_f32 v220, v16, v17
    v_cvt_pk_bf16_f32 v221, v18, v19
    v_mul_f32 v20, v20, v247
    v_mul_f32 v21, v21, v247
    v_mul_f32 v22, v22, v247
    v_mul_f32 v23, v23, v247
    v_cvt_pk_bf16_f32 v222, v20, v21
    v_cvt_pk_bf16_f32 v223, v22, v23
    v_mul_f32 v24, v24, v247
    v_mul_f32 v25, v25, v247
    v_mul_f32 v26, v26, v247
    v_mul_f32 v27, v27, v247
    v_cvt_pk_bf16_f32 v224, v24, v25
    v_cvt_pk_bf16_f32 v225, v26, v27
    v_mul_f32 v28, v28, v247
    v_mul_f32 v29, v29, v247
    v_mul_f32 v30, v30, v247
    v_mul_f32 v31, v31, v247
    v_cvt_pk_bf16_f32 v226, v28, v29
    v_cvt_pk_bf16_f32 v227, v30, v31
    ds_write_b64 v208, v[220:221]
    ds_write_b64 v209, v[222:223]
    ds_write_b64 v210, v[224:225]
    ds_write_b64 v211, v[226:227]
    ds_read_b128 v[240:243], v253 offset:0
    ds_read_b128 v[228:231], v253 offset:1024
    s_waitcnt lgkmcnt(6)
    buffer_store_dwordx4 v[232:235], v212, s[16:19], s46 offen offset:0 sc1
    buffer_store_dwordx4 v[236:239], v212, s[16:19], s47 offen offset:0 sc1
    v_mul_f32 v32, v32, v247
    v_mul_f32 v33, v33, v247
    v_mul_f32 v34, v34, v247
    v_mul_f32 v35, v35, v247
    v_cvt_pk_bf16_f32 v220, v32, v33
    v_cvt_pk_bf16_f32 v221, v34, v35
    v_mul_f32 v36, v36, v247
    v_mul_f32 v37, v37, v247
    v_mul_f32 v38, v38, v247
    v_mul_f32 v39, v39, v247
    v_cvt_pk_bf16_f32 v222, v36, v37
    v_cvt_pk_bf16_f32 v223, v38, v39
    v_mul_f32 v40, v40, v247
    v_mul_f32 v41, v41, v247
    v_mul_f32 v42, v42, v247
    v_mul_f32 v43, v43, v247
    v_cvt_pk_bf16_f32 v224, v40, v41
    v_cvt_pk_bf16_f32 v225, v42, v43
    v_mul_f32 v44, v44, v247
    v_mul_f32 v45, v45, v247
    v_mul_f32 v46, v46, v247
    v_mul_f32 v47, v47, v247
    v_cvt_pk_bf16_f32 v226, v44, v45
    v_cvt_pk_bf16_f32 v227, v46, v47
    ds_write_b64 v208, v[220:221]
    ds_write_b64 v209, v[222:223]
    ds_write_b64 v210, v[224:225]
    ds_write_b64 v211, v[226:227]
    ds_read_b128 v[232:235], v253 offset:0
    ds_read_b128 v[236:239], v253 offset:1024
    s_waitcnt lgkmcnt(6)
    buffer_store_dwordx4 v[240:243], v212, s[16:19], s46 offen offset:128 sc1
    buffer_store_dwordx4 v[228:231], v212, s[16:19], s47 offen offset:128 sc1
    s_waitcnt lgkmcnt(0)
    buffer_store_dwordx4 v[232:235], v212, s[16:19], s46 offen offset:256 sc1
    buffer_store_dwordx4 v[236:239], v212, s[16:19], s47 offen offset:256 sc1
    s_cmp_ge_u32 s24, 3
    s_cbranch_scc1 L_qr15
    s_mul_i32 s46, s24, 3
    s_mul_i32 s35, s46, 6144
    s_lshr_b32 s47, s46, 2
    s_cmp_ge_u32 s47, 2
    s_cselect_b32 s47, 147456, 0
    s_sub_u32 s35, s35, s47
    v_add_u32 v254, s35, v250
    v_xor_b32 v255, 64, v254
    ds_read_b128 v[144:147], v254 offset:0
    ds_read_b128 v[148:151], v255 offset:0
    ds_read_b128 v[152:155], v254 offset:1024
    ds_read_b128 v[156:159], v255 offset:1024
    ds_read_b128 v[160:163], v254 offset:2048
    ds_read_b128 v[164:167], v255 offset:2048
    s_waitcnt lgkmcnt(6)
L_qr15:
    s_cmp_ge_u32 s24, 3
    s_cbranch_scc1 L_qr16
    s_mul_i32 s46, s24, 3
    s_add_u32 s46, s46, 1
    s_mul_i32 s35, s46, 6144
    s_lshr_b32 s47, s46, 2
    s_cmp_ge_u32 s47, 2
    s_cselect_b32 s47, 147456, 0
    s_sub_u32 s35, s35, s47
    v_add_u32 v254, s35, v250
    v_xor_b32 v255, 64, v254
    ds_read_b128 v[168:171], v254 offset:0
    ds_read_b128 v[172:175], v255 offset:0
    ds_read_b128 v[176:179], v254 offset:1024
    ds_read_b128 v[180:183], v255 offset:1024
    ds_read_b128 v[184:187], v254 offset:2048
    ds_read_b128 v[188:191], v255 offset:2048
    s_waitcnt lgkmcnt(6)
L_qr16:
    s_cmp_ge_u32 s24, 2
    s_cbranch_scc1 L_qr17
    s_mul_i32 s46, s24, 3
    s_add_u32 s46, s46, 2
    s_mul_i32 s35, s46, 6144
    s_lshr_b32 s47, s46, 2
    s_cmp_ge_u32 s47, 2
    s_cselect_b32 s47, 147456, 0
    s_sub_u32 s35, s35, s47
    v_add_u32 v254, s35, v250
    v_xor_b32 v255, 64, v254
    ds_read_b128 v[192:195], v254 offset:0
    ds_read_b128 v[196:199], v255 offset:0
    ds_read_b128 v[200:203], v254 offset:1024
    ds_read_b128 v[204:207], v255 offset:1024
    ds_read_b128 v[0:3], v254 offset:2048
    ds_read_b128 v[4:7], v255 offset:2048
L_qr17:
    s_waitcnt lgkmcnt(0)
    s_waitcnt vmcnt(6)
    s_barrier
    s_add_u32 s46, s26, 196608
    s_add_u32 s47, s26, 98304
    s_add_u32 m0, s47, 0
    s_nop 0
    buffer_load_dwordx4 v252, s[12:15], s46 offen offset:0 nt lds
    s_add_u32 m0, s47, 896
    s_nop 0
    buffer_load_dwordx4 v252, s[12:15], s46 offen offset:128 nt lds
    s_add_u32 m0, s47, 1792
    s_nop 0
    buffer_load_dwordx4 v252, s[12:15], s46 offen offset:256 nt lds
    s_add_u32 s46, s26, 196608
    s_add_u32 s47, s26, 110592
    s_add_u32 m0, s47, 0
    s_nop 0
    buffer_load_dwordx4 v252, s[20:23], s46 offen offset:0 nt lds
    s_add_u32 m0, s47, 896
    s_nop 0
    buffer_load_dwordx4 v252, s[20:23], s46 offen offset:128 nt lds
    s_add_u32 m0, s47, 1792
    s_nop 0
    buffer_load_dwordx4 v252, s[20:23], s46 offen offset:256 nt lds
    s_add_u32 s46, s26, 86016
    s_add_u32 s47, s26, 36864
    s_add_u32 m0, s47, 0
    s_nop 0
    buffer_load_dwordx4 v252, s[4:7], s46 offen offset:0 nt lds
    s_add_u32 m0, s47, 896
    s_nop 0
    buffer_load_dwordx4 v252, s[4:7], s46 offen offset:128 nt lds
    s_add_u32 m0, s47, 1792
    s_nop 0
    buffer_load_dwordx4 v252, s[4:7], s46 offen offset:256 nt lds
    s_cmp_ge_u32 s24, 4
    s_cbranch_scc1 L_qr18
    s_cmp_lt_u32 s24, 3
    s_cbranch_scc1 L_qr18
    s_mul_i32 s46, s24, 3
    s_mul_i32 s35, s46, 6144
    s_lshr_b32 s47, s46, 2
    s_cmp_ge_u32 s47, 2
    s_cselect_b32 s47, 147456, 0
    s_sub_u32 s35, s35, s47
    v_add_u32 v254, s35, v250
    v_xor_b32 v255, 64, v254
    ds_read_b128 v[144:147], v254 offset:0
    ds_read_b128 v[148:151], v255 offset:0
    ds_read_b128 v[152:155], v254 offset:1024
    ds_read_b128 v[156:159], v255 offset:1024
    ds_read_b128 v[160:163], v254 offset:2048
    ds_read_b128 v[164:167], v255 offset:2048
    s_waitcnt lgkmcnt(6)
L_qr18:
    s_cmp_ge_u32 s24, 4
    s_cbranch_scc1 L_qr19
    s_cmp_lt_u32 s24, 3
    s_cbranch_scc1 L_qr19
    s_mul_i32 s46, s24, 3
    s_add_u32 s46, s46, 1
    s_mul_i32 s35, s46, 6144
    s_lshr_b32 s47, s46, 2
    s_cmp_ge_u32 s47, 2
    s_cselect_b32 s47, 147456, 0
    s_sub_u32 s35, s35, s47
    v_add_u32 v254, s35, v250
    v_xor_b32 v255, 64, v254
    ds_read_b128 v[168:171], v254 offset:0
    ds_read_b128 v[172:175], v255 offset:0
    ds_read_b128 v[176:179], v254 offset:1024
    ds_read_b128 v[180:183], v255 offset:1024
    ds_read_b128 v[184:187], v254 offset:2048
    ds_read_b128 v[188:191], v255 offset:2048
    s_waitcnt lgkmcnt(6)
L_qr19:
    s_cmp_ge_u32 s24, 4
    s_cbranch_scc1 L_qr20
    s_cmp_lt_u32 s24, 2
    s_cbranch_scc1 L_qr20
    s_mul_i32 s46, s24, 3
    s_add_u32 s46, s46, 2
    s_mul_i32 s35, s46, 6144
    s_lshr_b32 s47, s46, 2
    s_cmp_ge_u32 s47, 2
    s_cselect_b32 s47, 147456, 0
    s_sub_u32 s35, s35, s47
    v_add_u32 v254, s35, v250
    v_xor_b32 v255, 64, v254
    ds_read_b128 v[192:195], v254 offset:0
    ds_read_b128 v[196:199], v255 offset:0
    ds_read_b128 v[200:203], v254 offset:1024
    ds_read_b128 v[204:207], v255 offset:1024
    ds_read_b128 v[0:3], v254 offset:2048
    ds_read_b128 v[4:7], v255 offset:2048
L_qr20:
    s_waitcnt lgkmcnt(0)
    v_mov_b32 v254, v248
    s_nop 1
    v_permlane32_swap_b32 v248, v254
    v_add_f32 v248, v248, v254
    v_mov_b32 v254, v248
    s_nop 1
    v_permlane16_swap_b32 v248, v254
    v_add_f32 v248, v248, v254
    v_rcp_f32 v248, v248
    s_mov_b32 s46, 6144
    s_mov_b32 s47, 9216
    v_mul_f32 v48, v48, v248
    v_mul_f32 v49, v49, v248
    v_mul_f32 v50, v50, v248
    v_mul_f32 v51, v51, v248
    v_cvt_pk_bf16_f32 v220, v48, v49
    v_cvt_pk_bf16_f32 v221, v50, v51
    v_mul_f32 v52, v52, v248
    v_mul_f32 v53, v53, v248
    v_mul_f32 v54, v54, v248
    v_mul_f32 v55, v55, v248
    v_cvt_pk_bf16_f32 v222, v52, v53
    v_cvt_pk_bf16_f32 v223, v54, v55
    v_mul_f32 v56, v56, v248
    v_mul_f32 v57, v57, v248
    v_mul_f32 v58, v58, v248
    v_mul_f32 v59, v59, v248
    v_cvt_pk_bf16_f32 v224, v56, v57
    v_cvt_pk_bf16_f32 v225, v58, v59
    v_mul_f32 v60, v60, v248
    v_mul_f32 v61, v61, v248
    v_mul_f32 v62, v62, v248
    v_mul_f32 v63, v63, v248
    v_cvt_pk_bf16_f32 v226, v60, v61
    v_cvt_pk_bf16_f32 v227, v62, v63
    ds_write_b64 v208, v[220:221]
    ds_write_b64 v209, v[222:223]
    ds_write_b64 v210, v[224:225]
    ds_write_b64 v211, v[226:227]
    ds_read_b128 v[232:235], v253 offset:0
    ds_read_b128 v[236:239], v253 offset:1024
    v_mul_f32 v64, v64, v248
    v_mul_f32 v65, v65, v248
    v_mul_f32 v66, v66, v248
    v_mul_f32 v67, v67, v248
    v_cvt_pk_bf16_f32 v220, v64, v65
    v_cvt_pk_bf16_f32 v221, v66, v67
    v_mul_f32 v68, v68, v248
    v_mul_f32 v69, v69, v248
    v_mul_f32 v70, v70, v248
    v_mul_f32 v71, v71, v248
    v_cvt_pk_bf16_f32 v222, v68, v69
    v_cvt_pk_bf16_f32 v223, v70, v71
    v_mul_f32 v72, v72, v248
    v_mul_f32 v73, v73, v248
    v_mul_f32 v74, v74, v248
    v_mul_f32 v75, v75, v248
    v_cvt_pk_bf16_f32 v224, v72, v73
    v_cvt_pk_bf16_f32 v225, v74, v75
    v_mul_f32 v76, v76, v248
    v_mul_f32 v77, v77, v248
    v_mul_f32 v78, v78, v248
    v_mul_f32 v79, v79, v248
    v_cvt_pk_bf16_f32 v226, v76, v77
    v_cvt_pk_bf16_f32 v227, v78, v79
    ds_write_b64 v208, v[220:221]
    ds_write_b64 v209, v[222:223]
    ds_write_b64 v210, v[224:225]
    ds_write_b64 v211, v[226:227]
    ds_read_b128 v[240:243], v253 offset:0
    ds_read_b128 v[228:231], v253 offset:1024
    s_waitcnt lgkmcnt(6)
    buffer_store_dwordx4 v[232:235], v212, s[16:19], s46 offen offset:0 sc1
    buffer_store_dwordx4 v[236:239], v212, s[16:19], s47 offen offset:0 sc1
    v_mul_f32 v80, v80, v248
    v_mul_f32 v81, v81, v248
    v_mul_f32 v82, v82, v248
    v_mul_f32 v83, v83, v248
    v_cvt_pk_bf16_f32 v220, v80, v81
    v_cvt_pk_bf16_f32 v221, v82, v83
    v_mul_f32 v84, v84, v248
    v_mul_f32 v85, v85, v248
    v_mul_f32 v86, v86, v248
    v_mul_f32 v87, v87, v248
    v_cvt_pk_bf16_f32 v222, v84, v85
    v_cvt_pk_bf16_f32 v223, v86, v87
    v_mul_f32 v88, v88, v248
    v_mul_f32 v89, v89, v248
    v_mul_f32 v90, v90, v248
    v_mul_f32 v91, v91, v248
    v_cvt_pk_bf16_f32 v224, v88, v89
    v_cvt_pk_bf16_f32 v225, v90, v91
    v_mul_f32 v92, v92, v248
    v_mul_f32 v93, v93, v248
    v_mul_f32 v94, v94, v248
    v_mul_f32 v95, v95, v248
    v_cvt_pk_bf16_f32 v226, v92, v93
    v_cvt_pk_bf16_f32 v227, v94, v95
    ds_write_b64 v208, v[220:221]
    ds_write_b64 v209, v[222:223]
    ds_write_b64 v210, v[224:225]
    ds_write_b64 v211, v[226:227]
    ds_read_b128 v[232:235], v253 offset:0
    ds_read_b128 v[236:239], v253 offset:1024
    s_waitcnt lgkmcnt(6)
    buffer_store_dwordx4 v[240:243], v212, s[16:19], s46 offen offset:128 sc1
    buffer_store_dwordx4 v[228:231], v212, s[16:19], s47 offen offset:128 sc1
    s_waitcnt lgkmcnt(0)
    buffer_store_dwordx4 v[232:235], v212, s[16:19], s46 offen offset:256 sc1
    buffer_store_dwordx4 v[236:239], v212, s[16:19], s47 offen offset:256 sc1
    s_barrier
    s_add_u32 s46, s26, 208896
    s_add_u32 s47, s26, 122880
    s_add_u32 m0, s47, 0
    s_nop 0
    buffer_load_dwordx4 v252, s[12:15], s46 offen offset:0 nt lds
    s_add_u32 m0, s47, 896
    s_nop 0
    buffer_load_dwordx4 v252, s[12:15], s46 offen offset:128 nt lds
    s_add_u32 m0, s47, 1792
    s_nop 0
    buffer_load_dwordx4 v252, s[12:15], s46 offen offset:256 nt lds
    s_add_u32 s46, s26, 208896
    s_add_u32 s47, s26, 135168
    s_add_u32 m0, s47, 0
    s_nop 0
    buffer_load_dwordx4 v252, s[20:23], s46 offen offset:0 nt lds
    s_add_u32 m0, s47, 896
    s_nop 0
    buffer_load_dwordx4 v252, s[20:23], s46 offen offset:128 nt lds
    s_add_u32 m0, s47, 1792
    s_nop 0
    buffer_load_dwordx4 v252, s[20:23], s46 offen offset:256 nt lds
    s_add_u32 s46, s26, 221184
    s_add_u32 s47, s26, 0
    s_add_u32 m0, s47, 0
    s_nop 0
    buffer_load_dwordx4 v252, s[12:15], s46 offen offset:0 nt lds
    s_add_u32 m0, s47, 896
    s_nop 0
    buffer_load_dwordx4 v252, s[12:15], s46 offen offset:128 nt lds
    s_add_u32 m0, s47, 1792
    s_nop 0
    buffer_load_dwordx4 v252, s[12:15], s46 offen offset:256 nt lds
    v_mov_b32 v254, v249
    s_nop 1
    v_permlane32_swap_b32 v249, v254
    v_add_f32 v249, v249, v254
    v_mov_b32 v254, v249
    s_nop 1
    v_permlane16_swap_b32 v249, v254
    v_add_f32 v249, v249, v254
    v_rcp_f32 v249, v249
    s_mov_b32 s46, 12288
    s_mov_b32 s47, 15360
    v_mul_f32 v96, v96, v249
    v_mul_f32 v97, v97, v249
    v_mul_f32 v98, v98, v249
    v_mul_f32 v99, v99, v249
    v_cvt_pk_bf16_f32 v220, v96, v97
    v_cvt_pk_bf16_f32 v221, v98, v99
    v_mul_f32 v100, v100, v249
    v_mul_f32 v101, v101, v249
    v_mul_f32 v102, v102, v249
    v_mul_f32 v103, v103, v249
    v_cvt_pk_bf16_f32 v222, v100, v101
    v_cvt_pk_bf16_f32 v223, v102, v103
    v_mul_f32 v104, v104, v249
    v_mul_f32 v105, v105, v249
    v_mul_f32 v106, v106, v249
    v_mul_f32 v107, v107, v249
    v_cvt_pk_bf16_f32 v224, v104, v105
    v_cvt_pk_bf16_f32 v225, v106, v107
    v_mul_f32 v108, v108, v249
    v_mul_f32 v109, v109, v249
    v_mul_f32 v110, v110, v249
    v_mul_f32 v111, v111, v249
    v_cvt_pk_bf16_f32 v226, v108, v109
    v_cvt_pk_bf16_f32 v227, v110, v111
    ds_write_b64 v208, v[220:221]
    ds_write_b64 v209, v[222:223]
    ds_write_b64 v210, v[224:225]
    ds_write_b64 v211, v[226:227]
    ds_read_b128 v[232:235], v253 offset:0
    ds_read_b128 v[236:239], v253 offset:1024
    v_mul_f32 v112, v112, v249
    v_mul_f32 v113, v113, v249
    v_mul_f32 v114, v114, v249
    v_mul_f32 v115, v115, v249
    v_cvt_pk_bf16_f32 v220, v112, v113
    v_cvt_pk_bf16_f32 v221, v114, v115
    v_mul_f32 v116, v116, v249
    v_mul_f32 v117, v117, v249
    v_mul_f32 v118, v118, v249
    v_mul_f32 v119, v119, v249
    v_cvt_pk_bf16_f32 v222, v116, v117
    v_cvt_pk_bf16_f32 v223, v118, v119
    v_mul_f32 v120, v120, v249
    v_mul_f32 v121, v121, v249
    v_mul_f32 v122, v122, v249
    v_mul_f32 v123, v123, v249
    v_cvt_pk_bf16_f32 v224, v120, v121
    v_cvt_pk_bf16_f32 v225, v122, v123
    v_mul_f32 v124, v124, v249
    v_mul_f32 v125, v125, v249
    v_mul_f32 v126, v126, v249
    v_mul_f32 v127, v127, v249
    v_cvt_pk_bf16_f32 v226, v124, v125
    v_cvt_pk_bf16_f32 v227, v126, v127
    ds_write_b64 v208, v[220:221]
    ds_write_b64 v209, v[222:223]
    ds_write_b64 v210, v[224:225]
    ds_write_b64 v211, v[226:227]
    ds_read_b128 v[240:243], v253 offset:0
    ds_read_b128 v[228:231], v253 offset:1024
    s_waitcnt lgkmcnt(6)
    buffer_store_dwordx4 v[232:235], v212, s[16:19], s46 offen offset:0 sc1
    buffer_store_dwordx4 v[236:239], v212, s[16:19], s47 offen offset:0 sc1
    v_mul_f32 v128, v128, v249
    v_mul_f32 v129, v129, v249
    v_mul_f32 v130, v130, v249
    v_mul_f32 v131, v131, v249
    v_cvt_pk_bf16_f32 v220, v128, v129
    v_cvt_pk_bf16_f32 v221, v130, v131
    v_mul_f32 v132, v132, v249
    v_mul_f32 v133, v133, v249
    v_mul_f32 v134, v134, v249
    v_mul_f32 v135, v135, v249
    v_cvt_pk_bf16_f32 v222, v132, v133
    v_cvt_pk_bf16_f32 v223, v134, v135
    v_mul_f32 v136, v136, v249
    v_mul_f32 v137, v137, v249
    v_mul_f32 v138, v138, v249
    v_mul_f32 v139, v139, v249
    v_cvt_pk_bf16_f32 v224, v136, v137
    v_cvt_pk_bf16_f32 v225, v138, v139
    v_mul_f32 v140, v140, v249
    v_mul_f32 v141, v141, v249
    v_mul_f32 v142, v142, v249
    v_mul_f32 v143, v143, v249
    v_cvt_pk_bf16_f32 v226, v140, v141
    v_cvt_pk_bf16_f32 v227, v142, v143
    ds_write_b64 v208, v[220:221]
    ds_write_b64 v209, v[222:223]
    ds_write_b64 v210, v[224:225]
    ds_write_b64 v211, v[226:227]
    ds_read_b128 v[232:235], v253 offset:0
    ds_read_b128 v[236:239], v253 offset:1024
    s_waitcnt lgkmcnt(6)
    buffer_store_dwordx4 v[240:243], v212, s[16:19], s46 offen offset:128 sc1
    buffer_store_dwordx4 v[228:231], v212, s[16:19], s47 offen offset:128 sc1
    s_waitcnt lgkmcnt(0)
    buffer_store_dwordx4 v[232:235], v212, s[16:19], s46 offen offset:256 sc1
    buffer_store_dwordx4 v[236:239], v212, s[16:19], s47 offen offset:256 sc1
    s_barrier
    s_add_u32 s46, s26, 221184
    s_add_u32 s47, s26, 12288
    s_add_u32 m0, s47, 0
    s_nop 0
    buffer_load_dwordx4 v252, s[20:23], s46 offen offset:0 nt lds
    s_add_u32 m0, s47, 896
    s_nop 0
    buffer_load_dwordx4 v252, s[20:23], s46 offen offset:128 nt lds
    s_add_u32 m0, s47, 1792
    s_nop 0
    buffer_load_dwordx4 v252, s[20:23], s46 offen offset:256 nt lds
    s_add_u32 s46, s26, 110592
    s_add_u32 s47, s26, 61440
    s_add_u32 m0, s47, 0
    s_nop 0
    buffer_load_dwordx4 v252, s[4:7], s46 offen offset:0 nt lds
    s_add_u32 m0, s47, 896
    s_nop 0
    buffer_load_dwordx4 v252, s[4:7], s46 offen offset:128 nt lds
    s_add_u32 m0, s47, 1792
    s_nop 0
    buffer_load_dwordx4 v252, s[4:7], s46 offen offset:256 nt lds
    ds_write_b128 v253, v[0:3] offset:0
    ds_write_b128 v253, v[4:7] offset:1024
    s_waitcnt lgkmcnt(0)
    v_mov_b32 v244, 0xf149f2ca
    v_mov_b32 v247, 0
    v_mov_b32 v245, 0xf149f2ca
    v_mov_b32 v248, 0
    v_mov_b32 v246, 0xf149f2ca
    v_mov_b32 v249, 0
    s_cmp_eq_u32 s24, 7
    s_cbranch_scc0 L_pad21
    v_mov_b32 v246, 0x7149f2ca
L_pad21:
    s_waitcnt vmcnt(18)
    s_branch L_bnd_done
L_bnd_b:
    v_mbcnt_lo_u32_b32 v216, -1, 0
    v_mbcnt_hi_u32_b32 v216, -1, v216
    v_and_b32 v215, 15, v216
    v_lshrrev_b32 v216, 4, v216
    v_lshrrev_b32 v213, 1, v216
    v_and_b32 v214, 7, v215
    v_xor_b32 v213, v213, v214
    v_lshlrev_b32 v213, 4, v213
    v_and_b32 v214, 1, v216
    v_lshl_add_u32 v213, v214, 3, v213
    v_lshl_add_u32 v213, v215, 7, v213
    v_add_u32 v208, s37, v213
    v_xor_b32 v209, 32, v208
    v_xor_b32 v210, 64, v208
    v_xor_b32 v211, 96, v208
    v_lshl_add_u32 v213, v216, 4, v215
    v_lshrrev_b32 v214, 3, v213
    v_xor_b32 v213, v213, v214
    v_and_b32 v213, 7, v213
    v_lshlrev_b32 v213, 4, v213
    v_add_u32 v214, s36, v214
    v_mul_u32_u24 v214, 384, v214
    v_add_u32 v212, v213, v214
    v_mov_b32 v254, v247
    s_nop 1
    v_permlane32_swap_b32 v247, v254
    v_add_f32 v247, v247, v254
    v_mov_b32 v254, v247
    s_nop 1
    v_permlane16_swap_b32 v247, v254
    v_add_f32 v247, v247, v254
    v_rcp_f32 v247, v247
    s_mov_b32 s46, 0
    s_mov_b32 s47, 3072
    v_mul_f32 v0, v0, v247
    v_mul_f32 v1, v1, v247
    v_mul_f32 v2, v2, v247
    v_mul_f32 v3, v3, v247
    v_cvt_pk_bf16_f32 v220, v0, v1
    v_cvt_pk_bf16_f32 v221, v2, v3
    v_mul_f32 v4, v4, v247
    v_mul_f32 v5, v5, v247
    v_mul_f32 v6, v6, v247
    v_mul_f32 v7, v7, v247
    v_cvt_pk_bf16_f32 v222, v4, v5
    v_cvt_pk_bf16_f32 v223, v6, v7
    v_mul_f32 v8, v8, v247
    v_mul_f32 v9, v9, v247
    v_mul_f32 v10, v10, v247
    v_mul_f32 v11, v11, v247
    v_cvt_pk_bf16_f32 v224, v8, v9
    v_cvt_pk_bf16_f32 v225, v10, v11
    v_mul_f32 v12, v12, v247
    v_mul_f32 v13, v13, v247
    v_mul_f32 v14, v14, v247
    v_mul_f32 v15, v15, v247
    v_cvt_pk_bf16_f32 v226, v12, v13
    v_cvt_pk_bf16_f32 v227, v14, v15
    ds_write_b64 v208, v[220:221]
    ds_write_b64 v209, v[222:223]
    ds_write_b64 v210, v[224:225]
    ds_write_b64 v211, v[226:227]
    ds_read_b128 v[232:235], v253 offset:0
    ds_read_b128 v[236:239], v253 offset:1024
    v_mul_f32 v16, v16, v247
    v_mul_f32 v17, v17, v247
    v_mul_f32 v18, v18, v247
    v_mul_f32 v19, v19, v247
    v_cvt_pk_bf16_f32 v220, v16, v17
    v_cvt_pk_bf16_f32 v221, v18, v19
    v_mul_f32 v20, v20, v247
    v_mul_f32 v21, v21, v247
    v_mul_f32 v22, v22, v247
    v_mul_f32 v23, v23, v247
    v_cvt_pk_bf16_f32 v222, v20, v21
    v_cvt_pk_bf16_f32 v223, v22, v23
    v_mul_f32 v24, v24, v247
    v_mul_f32 v25, v25, v247
    v_mul_f32 v26, v26, v247
    v_mul_f32 v27, v27, v247
    v_cvt_pk_bf16_f32 v224, v24, v25
    v_cvt_pk_bf16_f32 v225, v26, v27
    v_mul_f32 v28, v28, v247
    v_mul_f32 v29, v29, v247
    v_mul_f32 v30, v30, v247
    v_mul_f32 v31, v31, v247
    v_cvt_pk_bf16_f32 v226, v28, v29
    v_cvt_pk_bf16_f32 v227, v30, v31
    ds_write_b64 v208, v[220:221]
    ds_write_b64 v209, v[222:223]
    ds_write_b64 v210, v[224:225]
    ds_write_b64 v211, v[226:227]
    ds_read_b128 v[240:243], v253 offset:0
    ds_read_b128 v[228:231], v253 offset:1024
    s_waitcnt lgkmcnt(6)
    buffer_store_dwordx4 v[232:235], v212, s[16:19], s46 offen offset:0 sc1
    buffer_store_dwordx4 v[236:239], v212, s[16:19], s47 offen offset:0 sc1
    v_mul_f32 v32, v32, v247
    v_mul_f32 v33, v33, v247
    v_mul_f32 v34, v34, v247
    v_mul_f32 v35, v35, v247
    v_cvt_pk_bf16_f32 v220, v32, v33
    v_cvt_pk_bf16_f32 v221, v34, v35
    v_mul_f32 v36, v36, v247
    v_mul_f32 v37, v37, v247
    v_mul_f32 v38, v38, v247
    v_mul_f32 v39, v39, v247
    v_cvt_pk_bf16_f32 v222, v36, v37
    v_cvt_pk_bf16_f32 v223, v38, v39
    v_mul_f32 v40, v40, v247
    v_mul_f32 v41, v41, v247
    v_mul_f32 v42, v42, v247
    v_mul_f32 v43, v43, v247
    v_cvt_pk_bf16_f32 v224, v40, v41
    v_cvt_pk_bf16_f32 v225, v42, v43
    v_mul_f32 v44, v44, v247
    v_mul_f32 v45, v45, v247
    v_mul_f32 v46, v46, v247
    v_mul_f32 v47, v47, v247
    v_cvt_pk_bf16_f32 v226, v44, v45
    v_cvt_pk_bf16_f32 v227, v46, v47
    ds_write_b64 v208, v[220:221]
    ds_write_b64 v209, v[222:223]
    ds_write_b64 v210, v[224:225]
    ds_write_b64 v211, v[226:227]
    ds_read_b128 v[232:235], v253 offset:0
    ds_read_b128 v[236:239], v253 offset:1024
    s_waitcnt lgkmcnt(6)
    buffer_store_dwordx4 v[240:243], v212, s[16:19], s46 offen offset:128 sc1
    buffer_store_dwordx4 v[228:231], v212, s[16:19], s47 offen offset:128 sc1
    s_waitcnt lgkmcnt(0)
    buffer_store_dwordx4 v[232:235], v212, s[16:19], s46 offen offset:256 sc1
    buffer_store_dwordx4 v[236:239], v212, s[16:19], s47 offen offset:256 sc1
    s_cmp_ge_u32 s24, 7
    s_cbranch_scc1 L_qr22
    s_cmp_lt_u32 s24, 4
    s_cbranch_scc1 L_qr22
    s_mul_i32 s46, s24, 3
    s_mul_i32 s35, s46, 6144
    s_lshr_b32 s47, s46, 2
    s_cmp_ge_u32 s47, 2
    s_cselect_b32 s47, 147456, 0
    s_sub_u32 s35, s35, s47
    v_add_u32 v254, s35, v250
    v_xor_b32 v255, 64, v254
    ds_read_b128 v[144:147], v254 offset:0
    ds_read_b128 v[148:151], v255 offset:0
    ds_read_b128 v[152:155], v254 offset:1024
    ds_read_b128 v[156:159], v255 offset:1024
    ds_read_b128 v[160:163], v254 offset:2048
    ds_read_b128 v[164:167], v255 offset:2048
    s_waitcnt lgkmcnt(6)
L_qr22:
    s_cmp_ge_u32 s24, 7
    s_cbranch_scc1 L_qr23
    s_cmp_lt_u32 s24, 4
    s_cbranch_scc1 L_qr23
    s_mul_i32 s46, s24, 3
    s_add_u32 s46, s46, 1
    s_mul_i32 s35, s46, 6144
    s_lshr_b32 s47, s46, 2
    s_cmp_ge_u32 s47, 2
    s_cselect_b32 s47, 147456, 0
    s_sub_u32 s35, s35, s47
    v_add_u32 v254, s35, v250
    v_xor_b32 v255, 64, v254
    ds_read_b128 v[168:171], v254 offset:0
    ds_read_b128 v[172:175], v255 offset:0
    ds_read_b128 v[176:179], v254 offset:1024
    ds_read_b128 v[180:183], v255 offset:1024
    ds_read_b128 v[184:187], v254 offset:2048
    ds_read_b128 v[188:191], v255 offset:2048
    s_waitcnt lgkmcnt(6)
L_qr23:
    s_cmp_ge_u32 s24, 6
    s_cbranch_scc1 L_qr24
    s_cmp_lt_u32 s24, 4
    s_cbranch_scc1 L_qr24
    s_mul_i32 s46, s24, 3
    s_add_u32 s46, s46, 2
    s_mul_i32 s35, s46, 6144
    s_lshr_b32 s47, s46, 2
    s_cmp_ge_u32 s47, 2
    s_cselect_b32 s47, 147456, 0
    s_sub_u32 s35, s35, s47
    v_add_u32 v254, s35, v250
    v_xor_b32 v255, 64, v254
    ds_read_b128 v[192:195], v254 offset:0
    ds_read_b128 v[196:199], v255 offset:0
    ds_read_b128 v[200:203], v254 offset:1024
    ds_read_b128 v[204:207], v255 offset:1024
    ds_read_b128 v[0:3], v254 offset:2048
    ds_read_b128 v[4:7], v255 offset:2048
L_qr24:
    s_waitcnt lgkmcnt(0)
    s_barrier
    s_add_u32 s46, s26, 233472
    s_add_u32 s47, s26, 24576
    s_add_u32 m0, s47, 0
    s_nop 0
    buffer_load_dwordx4 v252, s[12:15], s46 offen offset:0 nt lds
    s_add_u32 m0, s47, 896
    s_nop 0
    buffer_load_dwordx4 v252, s[12:15], s46 offen offset:128 nt lds
    s_add_u32 m0, s47, 1792
    s_nop 0
    buffer_load_dwordx4 v252, s[12:15], s46 offen offset:256 nt lds
    s_add_u32 s46, s26, 233472
    s_add_u32 s47, s26, 36864
    s_add_u32 m0, s47, 0
    s_nop 0
    buffer_load_dwordx4 v252, s[20:23], s46 offen offset:0 nt lds
    s_add_u32 m0, s47, 896
    s_nop 0
    buffer_load_dwordx4 v252, s[20:23], s46 offen offset:128 nt lds
    s_add_u32 m0, s47, 1792
    s_nop 0
    buffer_load_dwordx4 v252, s[20:23], s46 offen offset:256 nt lds
    v_mov_b32 v254, v248
    s_nop 1
    v_permlane32_swap_b32 v248, v254
    v_add_f32 v248, v248, v254
    v_mov_b32 v254, v248
    s_nop 1
    v_permlane16_swap_b32 v248, v254
    v_add_f32 v248, v248, v254
    v_rcp_f32 v248, v248
    s_mov_b32 s46, 6144
    s_mov_b32 s47, 9216
    v_mul_f32 v48, v48, v248
    v_mul_f32 v49, v49, v248
    v_mul_f32 v50, v50, v248
    v_mul_f32 v51, v51, v248
    v_cvt_pk_bf16_f32 v220, v48, v49
    v_cvt_pk_bf16_f32 v221, v50, v51
    v_mul_f32 v52, v52, v248
    v_mul_f32 v53, v53, v248
    v_mul_f32 v54, v54, v248
    v_mul_f32 v55, v55, v248
    v_cvt_pk_bf16_f32 v222, v52, v53
    v_cvt_pk_bf16_f32 v223, v54, v55
    v_mul_f32 v56, v56, v248
    v_mul_f32 v57, v57, v248
    v_mul_f32 v58, v58, v248
    v_mul_f32 v59, v59, v248
    v_cvt_pk_bf16_f32 v224, v56, v57
    v_cvt_pk_bf16_f32 v225, v58, v59
    v_mul_f32 v60, v60, v248
    v_mul_f32 v61, v61, v248
    v_mul_f32 v62, v62, v248
    v_mul_f32 v63, v63, v248
    v_cvt_pk_bf16_f32 v226, v60, v61
    v_cvt_pk_bf16_f32 v227, v62, v63
    ds_write_b64 v208, v[220:221]
    ds_write_b64 v209, v[222:223]
    ds_write_b64 v210, v[224:225]
    ds_write_b64 v211, v[226:227]
    ds_read_b128 v[232:235], v253 offset:0
    ds_read_b128 v[236:239], v253 offset:1024
    v_mul_f32 v64, v64, v248
    v_mul_f32 v65, v65, v248
    v_mul_f32 v66, v66, v248
    v_mul_f32 v67, v67, v248
    v_cvt_pk_bf16_f32 v220, v64, v65
    v_cvt_pk_bf16_f32 v221, v66, v67
    v_mul_f32 v68, v68, v248
    v_mul_f32 v69, v69, v248
    v_mul_f32 v70, v70, v248
    v_mul_f32 v71, v71, v248
    v_cvt_pk_bf16_f32 v222, v68, v69
    v_cvt_pk_bf16_f32 v223, v70, v71
    v_mul_f32 v72, v72, v248
    v_mul_f32 v73, v73, v248
    v_mul_f32 v74, v74, v248
    v_mul_f32 v75, v75, v248
    v_cvt_pk_bf16_f32 v224, v72, v73
    v_cvt_pk_bf16_f32 v225, v74, v75
    v_mul_f32 v76, v76, v248
    v_mul_f32 v77, v77, v248
    v_mul_f32 v78, v78, v248
    v_mul_f32 v79, v79, v248
    v_cvt_pk_bf16_f32 v226, v76, v77
    v_cvt_pk_bf16_f32 v227, v78, v79
    ds_write_b64 v208, v[220:221]
    ds_write_b64 v209, v[222:223]
    ds_write_b64 v210, v[224:225]
    ds_write_b64 v211, v[226:227]
    ds_read_b128 v[240:243], v253 offset:0
    ds_read_b128 v[228:231], v253 offset:1024
    s_waitcnt lgkmcnt(6)
    buffer_store_dwordx4 v[232:235], v212, s[16:19], s46 offen offset:0 sc1
    buffer_store_dwordx4 v[236:239], v212, s[16:19], s47 offen offset:0 sc1
    v_mul_f32 v80, v80, v248
    v_mul_f32 v81, v81, v248
    v_mul_f32 v82, v82, v248
    v_mul_f32 v83, v83, v248
    v_cvt_pk_bf16_f32 v220, v80, v81
    v_cvt_pk_bf16_f32 v221, v82, v83
    v_mul_f32 v84, v84, v248
    v_mul_f32 v85, v85, v248
    v_mul_f32 v86, v86, v248
    v_mul_f32 v87, v87, v248
    v_cvt_pk_bf16_f32 v222, v84, v85
    v_cvt_pk_bf16_f32 v223, v86, v87
    v_mul_f32 v88, v88, v248
    v_mul_f32 v89, v89, v248
    v_mul_f32 v90, v90, v248
    v_mul_f32 v91, v91, v248
    v_cvt_pk_bf16_f32 v224, v88, v89
    v_cvt_pk_bf16_f32 v225, v90, v91
    v_mul_f32 v92, v92, v248
    v_mul_f32 v93, v93, v248
    v_mul_f32 v94, v94, v248
    v_mul_f32 v95, v95, v248
    v_cvt_pk_bf16_f32 v226, v92, v93
    v_cvt_pk_bf16_f32 v227, v94, v95
    ds_write_b64 v208, v[220:221]
    ds_write_b64 v209, v[222:223]
    ds_write_b64 v210, v[224:225]
    ds_write_b64 v211, v[226:227]
    ds_read_b128 v[232:235], v253 offset:0
    ds_read_b128 v[236:239], v253 offset:1024
    s_waitcnt lgkmcnt(6)
    buffer_store_dwordx4 v[240:243], v212, s[16:19], s46 offen offset:128 sc1
    buffer_store_dwordx4 v[228:231], v212, s[16:19], s47 offen offset:128 sc1
    s_waitcnt lgkmcnt(0)
    buffer_store_dwordx4 v[232:235], v212, s[16:19], s46 offen offset:256 sc1
    buffer_store_dwordx4 v[236:239], v212, s[16:19], s47 offen offset:256 sc1
    s_waitcnt vmcnt(18)
    s_barrier
    s_add_u32 s46, s26, 245760
    s_add_u32 s47, s26, 49152
    s_add_u32 m0, s47, 0
    s_nop 0
    buffer_load_dwordx4 v252, s[12:15], s46 offen offset:0 nt lds
    s_add_u32 m0, s47, 896
    s_nop 0
    buffer_load_dwordx4 v252, s[12:15], s46 offen offset:128 nt lds
    s_add_u32 m0, s47, 1792
    s_nop 0
    buffer_load_dwordx4 v252, s[12:15], s46 offen offset:256 nt lds
    s_add_u32 s46, s26, 245760
    s_add_u32 s47, s26, 61440
    s_add_u32 m0, s47, 0
    s_nop 0
    buffer_load_dwordx4 v252, s[20:23], s46 offen offset:0 nt lds
    s_add_u32 m0, s47, 896
    s_nop 0
    buffer_load_dwordx4 v252, s[20:23], s46 offen offset:128 nt lds
    s_add_u32 m0, s47, 1792
    s_nop 0
    buffer_load_dwordx4 v252, s[20:23], s46 offen offset:256 nt lds
    s_cmp_ge_u32 s24, 8
    s_cbranch_scc1 L_qr25
    s_cmp_lt_u32 s24, 7
    s_cbranch_scc1 L_qr25
    s_mul_i32 s46, s24, 3
    s_mul_i32 s35, s46, 6144
    s_lshr_b32 s47, s46, 2
    s_cmp_ge_u32 s47, 2
    s_cselect_b32 s47, 147456, 0
    s_sub_u32 s35, s35, s47
    v_add_u32 v254, s35, v250
    v_xor_b32 v255, 64, v254
    ds_read_b128 v[144:147], v254 offset:0
    ds_read_b128 v[148:151], v255 offset:0
    ds_read_b128 v[152:155], v254 offset:1024
    ds_read_b128 v[156:159], v255 offset:1024
    ds_read_b128 v[160:163], v254 offset:2048
    ds_read_b128 v[164:167], v255 offset:2048
    s_waitcnt lgkmcnt(6)
L_qr25:
    s_cmp_ge_u32 s24, 8
    s_cbranch_scc1 L_qr26
    s_cmp_lt_u32 s24, 7
    s_cbranch_scc1 L_qr26
    s_mul_i32 s46, s24, 3
    s_add_u32 s46, s46, 1
    s_mul_i32 s35, s46, 6144
    s_lshr_b32 s47, s46, 2
    s_cmp_ge_u32 s47, 2
    s_cselect_b32 s47, 147456, 0
    s_sub_u32 s35, s35, s47
    v_add_u32 v254, s35, v250
    v_xor_b32 v255, 64, v254
    ds_read_b128 v[168:171], v254 offset:0
    ds_read_b128 v[172:175], v255 offset:0
    ds_read_b128 v[176:179], v254 offset:1024
    ds_read_b128 v[180:183], v255 offset:1024
    ds_read_b128 v[184:187], v254 offset:2048
    ds_read_b128 v[188:191], v255 offset:2048
    s_waitcnt lgkmcnt(6)
L_qr26:
    s_cmp_ge_u32 s24, 8
    s_cbranch_scc1 L_qr27
    s_cmp_lt_u32 s24, 6
    s_cbranch_scc1 L_qr27
    s_mul_i32 s46, s24, 3
    s_add_u32 s46, s46, 2
    s_mul_i32 s35, s46, 6144
    s_lshr_b32 s47, s46, 2
    s_cmp_ge_u32 s47, 2
    s_cselect_b32 s47, 147456, 0
    s_sub_u32 s35, s35, s47
    v_add_u32 v254, s35, v250
    v_xor_b32 v255, 64, v254
    ds_read_b128 v[192:195], v254 offset:0
    ds_read_b128 v[196:199], v255 offset:0
    ds_read_b128 v[200:203], v254 offset:1024
    ds_read_b128 v[204:207], v255 offset:1024
    ds_read_b128 v[0:3], v254 offset:2048
    ds_read_b128 v[4:7], v255 offset:2048
L_qr27:
    s_waitcnt lgkmcnt(0)
    v_mov_b32 v254, v249
    s_nop 1
    v_permlane32_swap_b32 v249, v254
    v_add_f32 v249, v249, v254
    v_mov_b32 v254, v249
    s_nop 1
    v_permlane16_swap_b32 v249, v254
    v_add_f32 v249, v249, v254
    v_rcp_f32 v249, v249
    s_mov_b32 s46, 12288
    s_mov_b32 s47, 15360
    v_mul_f32 v96, v96, v249
    v_mul_f32 v97, v97, v249
    v_mul_f32 v98, v98, v249
    v_mul_f32 v99, v99, v249
    v_cvt_pk_bf16_f32 v220, v96, v97
    v_cvt_pk_bf16_f32 v221, v98, v99
    v_mul_f32 v100, v100, v249
    v_mul_f32 v101, v101, v249
    v_mul_f32 v102, v102, v249
    v_mul_f32 v103, v103, v249
    v_cvt_pk_bf16_f32 v222, v100, v101
    v_cvt_pk_bf16_f32 v223, v102, v103
    v_mul_f32 v104, v104, v249
    v_mul_f32 v105, v105, v249
    v_mul_f32 v106, v106, v249
    v_mul_f32 v107, v107, v249
    v_cvt_pk_bf16_f32 v224, v104, v105
    v_cvt_pk_bf16_f32 v225, v106, v107
    v_mul_f32 v108, v108, v249
    v_mul_f32 v109, v109, v249
    v_mul_f32 v110, v110, v249
    v_mul_f32 v111, v111, v249
    v_cvt_pk_bf16_f32 v226, v108, v109
    v_cvt_pk_bf16_f32 v227, v110, v111
    ds_write_b64 v208, v[220:221]
    ds_write_b64 v209, v[222:223]
    ds_write_b64 v210, v[224:225]
    ds_write_b64 v211, v[226:227]
    ds_read_b128 v[232:235], v253 offset:0
    ds_read_b128 v[236:239], v253 offset:1024
    v_mul_f32 v112, v112, v249
    v_mul_f32 v113, v113, v249
    v_mul_f32 v114, v114, v249
    v_mul_f32 v115, v115, v249
    v_cvt_pk_bf16_f32 v220, v112, v113
    v_cvt_pk_bf16_f32 v221, v114, v115
    v_mul_f32 v116, v116, v249
    v_mul_f32 v117, v117, v249
    v_mul_f32 v118, v118, v249
    v_mul_f32 v119, v119, v249
    v_cvt_pk_bf16_f32 v222, v116, v117
    v_cvt_pk_bf16_f32 v223, v118, v119
    v_mul_f32 v120, v120, v249
    v_mul_f32 v121, v121, v249
    v_mul_f32 v122, v122, v249
    v_mul_f32 v123, v123, v249
    v_cvt_pk_bf16_f32 v224, v120, v121
    v_cvt_pk_bf16_f32 v225, v122, v123
    v_mul_f32 v124, v124, v249
    v_mul_f32 v125, v125, v249
    v_mul_f32 v126, v126, v249
    v_mul_f32 v127, v127, v249
    v_cvt_pk_bf16_f32 v226, v124, v125
    v_cvt_pk_bf16_f32 v227, v126, v127
    ds_write_b64 v208, v[220:221]
    ds_write_b64 v209, v[222:223]
    ds_write_b64 v210, v[224:225]
    ds_write_b64 v211, v[226:227]
    ds_read_b128 v[240:243], v253 offset:0
    ds_read_b128 v[228:231], v253 offset:1024
    s_waitcnt lgkmcnt(6)
    buffer_store_dwordx4 v[232:235], v212, s[16:19], s46 offen offset:0 sc1
    buffer_store_dwordx4 v[236:239], v212, s[16:19], s47 offen offset:0 sc1
    v_mul_f32 v128, v128, v249
    v_mul_f32 v129, v129, v249
    v_mul_f32 v130, v130, v249
    v_mul_f32 v131, v131, v249
    v_cvt_pk_bf16_f32 v220, v128, v129
    v_cvt_pk_bf16_f32 v221, v130, v131
    v_mul_f32 v132, v132, v249
    v_mul_f32 v133, v133, v249
    v_mul_f32 v134, v134, v249
    v_mul_f32 v135, v135, v249
    v_cvt_pk_bf16_f32 v222, v132, v133
    v_cvt_pk_bf16_f32 v223, v134, v135
    v_mul_f32 v136, v136, v249
    v_mul_f32 v137, v137, v249
    v_mul_f32 v138, v138, v249
    v_mul_f32 v139, v139, v249
    v_cvt_pk_bf16_f32 v224, v136, v137
    v_cvt_pk_bf16_f32 v225, v138, v139
    v_mul_f32 v140, v140, v249
    v_mul_f32 v141, v141, v249
    v_mul_f32 v142, v142, v249
    v_mul_f32 v143, v143, v249
    v_cvt_pk_bf16_f32 v226, v140, v141
    v_cvt_pk_bf16_f32 v227, v142, v143
    ds_write_b64 v208, v[220:221]
    ds_write_b64 v209, v[222:223]
    ds_write_b64 v210, v[224:225]
    ds_write_b64 v211, v[226:227]
    ds_read_b128 v[232:235], v253 offset:0
    ds_read_b128 v[236:239], v253 offset:1024
    s_waitcnt lgkmcnt(6)
    buffer_store_dwordx4 v[240:243], v212, s[16:19], s46 offen offset:128 sc1
    buffer_store_dwordx4 v[228:231], v212, s[16:19], s47 offen offset:128 sc1
    s_waitcnt lgkmcnt(0)
    buffer_store_dwordx4 v[232:235], v212, s[16:19], s46 offen offset:256 sc1
    buffer_store_dwordx4 v[236:239], v212, s[16:19], s47 offen offset:256 sc1
    s_barrier
    s_add_u32 s46, s26, 258048
    s_add_u32 s47, s26, 73728
    s_add_u32 m0, s47, 0
    s_nop 0
    buffer_load_dwordx4 v252, s[12:15], s46 offen offset:0 nt lds
    s_add_u32 m0, s47, 896
    s_nop 0
    buffer_load_dwordx4 v252, s[12:15], s46 offen offset:128 nt lds
    s_add_u32 m0, s47, 1792
    s_nop 0
    buffer_load_dwordx4 v252, s[12:15], s46 offen offset:256 nt lds
    ds_write_b128 v253, v[0:3] offset:0
    ds_write_b128 v253, v[4:7] offset:1024
    s_waitcnt lgkmcnt(0)
    v_mov_b32 v244, 0xf149f2ca
    v_mov_b32 v247, 0
    v_mov_b32 v245, 0xf149f2ca
    v_mov_b32 v248, 0
    v_mov_b32 v246, 0xf149f2ca
    v_mov_b32 v249, 0
    s_cmp_eq_u32 s24, 7
    s_cbranch_scc0 L_pad28
    v_mov_b32 v246, 0x7149f2ca
L_pad28:
    s_waitcnt vmcnt(24)
L_bnd_done:
    s_add_u32 s16, s16, 141312
    s_addc_u32 s17, s17, 0
    s_barrier
    s_setprio 2
    s_branch L_slow
L_pv_spec:
    s_cmp_lg_u32 s25, 0
    s_cbranch_scc1 L_pv_b
    s_cmp_eq_u32 s29, 17
    s_cbranch_scc1 L_pv_done
    s_cmp_lt_u32 s29, 16
    s_cbranch_scc1 L_pv_early
    s_add_u32 s46, s26, 135168
    s_add_u32 s47, s26, 86016
    s_add_u32 m0, s47, 0
    s_nop 0
    buffer_load_dwordx4 v252, s[4:7], s46 offen offset:0 nt lds
    s_add_u32 m0, s47, 896
    s_nop 0
    buffer_load_dwordx4 v252, s[4:7], s46 offen offset:128 nt lds
    s_add_u32 m0, s47, 1792
    s_nop 0
    buffer_load_dwordx4 v252, s[4:7], s46 offen offset:256 nt lds
    s_branch L_pv_done
L_pv_early:
    s_cmp_eq_u32 s29, 1
    s_cbranch_scc1 L_pv_done
    s_cmp_eq_u32 s29, 3
    s_cbranch_scc1 L_pv_e3
    s_add_u32 s46, s26, 49152
    s_add_u32 s47, s26, 110592
    s_add_u32 m0, s47, 0
    s_nop 0
    buffer_load_dwordx4 v252, s[20:23], s46 offen offset:0 nt lds
    s_add_u32 m0, s47, 896
    s_nop 0
    buffer_load_dwordx4 v252, s[20:23], s46 offen offset:128 nt lds
    s_add_u32 m0, s47, 1792
    s_nop 0
    buffer_load_dwordx4 v252, s[20:23], s46 offen offset:256 nt lds
    s_branch L_pv_done
L_pv_e3:
    s_add_u32 s46, s26, 61440
    s_add_u32 s47, s26, 135168
    s_add_u32 m0, s47, 0
    s_nop 0
    buffer_load_dwordx4 v252, s[20:23], s46 offen offset:0 nt lds
    s_add_u32 m0, s47, 896
    s_nop 0
    buffer_load_dwordx4 v252, s[20:23], s46 offen offset:128 nt lds
    s_add_u32 m0, s47, 1792
    s_nop 0
    buffer_load_dwordx4 v252, s[20:23], s46 offen offset:256 nt lds
    s_branch L_pv_reg
L_pv_b:
    s_add_u32 s46, s26, 61440
    s_add_u32 s47, s26, 122880
    s_add_u32 m0, s47, 0
    s_nop 0
    buffer_load_dwordx4 v252, s[12:15], s46 offen offset:0 nt lds
    s_add_u32 m0, s47, 896
    s_nop 0
    buffer_load_dwordx4 v252, s[12:15], s46 offen offset:128 nt lds
    s_add_u32 m0, s47, 1792
    s_nop 0
    buffer_load_dwordx4 v252, s[12:15], s46 offen offset:256 nt lds
    s_branch L_pv_reg
L_final:
    s_setprio 0
    s_nop 7
    s_cmp_lg_u32 s25, 0
    s_cbranch_scc1 L_fin_b
    s_barrier
    v_mbcnt_lo_u32_b32 v216, -1, 0
    v_mbcnt_hi_u32_b32 v216, -1, v216
    v_and_b32 v215, 15, v216
    v_lshrrev_b32 v216, 4, v216
    v_lshrrev_b32 v213, 1, v216
    v_and_b32 v214, 7, v215
    v_xor_b32 v213, v213, v214
    v_lshlrev_b32 v213, 4, v213
    v_and_b32 v214, 1, v216
    v_lshl_add_u32 v213, v214, 3, v213
    v_lshl_add_u32 v213, v215, 7, v213
    v_add_u32 v208, s37, v213
    v_xor_b32 v209, 32, v208
    v_xor_b32 v210, 64, v208
    v_xor_b32 v211, 96, v208
    v_lshl_add_u32 v213, v216, 4, v215
    v_lshrrev_b32 v214, 3, v213
    v_xor_b32 v213, v213, v214
    v_and_b32 v213, 7, v213
    v_lshlrev_b32 v213, 4, v213
    v_add_u32 v214, s36, v214
    v_mul_u32_u24 v214, 384, v214
    v_add_u32 v212, v213, v214
    v_mov_b32 v254, v247
    s_nop 1
    v_permlane32_swap_b32 v247, v254
    v_add_f32 v247, v247, v254
    v_mov_b32 v254, v247
    s_nop 1
    v_permlane16_swap_b32 v247, v254
    v_add_f32 v247, v247, v254
    v_rcp_f32 v247, v247
    s_mov_b32 s46, 0
    s_mov_b32 s47, 3072
    v_mul_f32 v0, v0, v247
    v_mul_f32 v1, v1, v247
    v_mul_f32 v2, v2, v247
    v_mul_f32 v3, v3, v247
    v_cvt_pk_bf16_f32 v220, v0, v1
    v_cvt_pk_bf16_f32 v221, v2, v3
    v_mul_f32 v4, v4, v247
    v_mul_f32 v5, v5, v247
    v_mul_f32 v6, v6, v247
    v_mul_f32 v7, v7, v247
    v_cvt_pk_bf16_f32 v222, v4, v5
    v_cvt_pk_bf16_f32 v223, v6, v7
    v_mul_f32 v8, v8, v247
    v_mul_f32 v9, v9, v247
    v_mul_f32 v10, v10, v247
    v_mul_f32 v11, v11, v247
    v_cvt_pk_bf16_f32 v224, v8, v9
    v_cvt_pk_bf16_f32 v225, v10, v11
    v_mul_f32 v12, v12, v247
    v_mul_f32 v13, v13, v247
    v_mul_f32 v14, v14, v247
    v_mul_f32 v15, v15, v247
    v_cvt_pk_bf16_f32 v226, v12, v13
    v_cvt_pk_bf16_f32 v227, v14, v15
    ds_write_b64 v208, v[220:221]
    ds_write_b64 v209, v[222:223]
    ds_write_b64 v210, v[224:225]
    ds_write_b64 v211, v[226:227]
    ds_read_b128 v[232:235], v253 offset:0
    ds_read_b128 v[236:239], v253 offset:1024
    v_mul_f32 v16, v16, v247
    v_mul_f32 v17, v17, v247
    v_mul_f32 v18, v18, v247
    v_mul_f32 v19, v19, v247
    v_cvt_pk_bf16_f32 v220, v16, v17
    v_cvt_pk_bf16_f32 v221, v18, v19
    v_mul_f32 v20, v20, v247
    v_mul_f32 v21, v21, v247
    v_mul_f32 v22, v22, v247
    v_mul_f32 v23, v23, v247
    v_cvt_pk_bf16_f32 v222, v20, v21
    v_cvt_pk_bf16_f32 v223, v22, v23
    v_mul_f32 v24, v24, v247
    v_mul_f32 v25, v25, v247
    v_mul_f32 v26, v26, v247
    v_mul_f32 v27, v27, v247
    v_cvt_pk_bf16_f32 v224, v24, v25
    v_cvt_pk_bf16_f32 v225, v26, v27
    v_mul_f32 v28, v28, v247
    v_mul_f32 v29, v29, v247
    v_mul_f32 v30, v30, v247
    v_mul_f32 v31, v31, v247
    v_cvt_pk_bf16_f32 v226, v28, v29
    v_cvt_pk_bf16_f32 v227, v30, v31
    ds_write_b64 v208, v[220:221]
    ds_write_b64 v209, v[222:223]
    ds_write_b64 v210, v[224:225]
    ds_write_b64 v211, v[226:227]
    ds_read_b128 v[240:243], v253 offset:0
    ds_read_b128 v[228:231], v253 offset:1024
    s_waitcnt lgkmcnt(6)
    buffer_store_dwordx4 v[232:235], v212, s[16:19], s46 offen offset:0 sc1
    buffer_store_dwordx4 v[236:239], v212, s[16:19], s47 offen offset:0 sc1
    v_mul_f32 v32, v32, v247
    v_mul_f32 v33, v33, v247
    v_mul_f32 v34, v34, v247
    v_mul_f32 v35, v35, v247
    v_cvt_pk_bf16_f32 v220, v32, v33
    v_cvt_pk_bf16_f32 v221, v34, v35
    v_mul_f32 v36, v36, v247
    v_mul_f32 v37, v37, v247
    v_mul_f32 v38, v38, v247
    v_mul_f32 v39, v39, v247
    v_cvt_pk_bf16_f32 v222, v36, v37
    v_cvt_pk_bf16_f32 v223, v38, v39
    v_mul_f32 v40, v40, v247
    v_mul_f32 v41, v41, v247
    v_mul_f32 v42, v42, v247
    v_mul_f32 v43, v43, v247
    v_cvt_pk_bf16_f32 v224, v40, v41
    v_cvt_pk_bf16_f32 v225, v42, v43
    v_mul_f32 v44, v44, v247
    v_mul_f32 v45, v45, v247
    v_mul_f32 v46, v46, v247
    v_mul_f32 v47, v47, v247
    v_cvt_pk_bf16_f32 v226, v44, v45
    v_cvt_pk_bf16_f32 v227, v46, v47
    ds_write_b64 v208, v[220:221]
    ds_write_b64 v209, v[222:223]
    ds_write_b64 v210, v[224:225]
    ds_write_b64 v211, v[226:227]
    ds_read_b128 v[232:235], v253 offset:0
    ds_read_b128 v[236:239], v253 offset:1024
    s_waitcnt lgkmcnt(6)
    buffer_store_dwordx4 v[240:243], v212, s[16:19], s46 offen offset:128 sc1
    buffer_store_dwordx4 v[228:231], v212, s[16:19], s47 offen offset:128 sc1
    s_waitcnt lgkmcnt(0)
    buffer_store_dwordx4 v[232:235], v212, s[16:19], s46 offen offset:256 sc1
    buffer_store_dwordx4 v[236:239], v212, s[16:19], s47 offen offset:256 sc1
    s_barrier
    s_barrier
    v_mov_b32 v254, v248
    s_nop 1
    v_permlane32_swap_b32 v248, v254
    v_add_f32 v248, v248, v254
    v_mov_b32 v254, v248
    s_nop 1
    v_permlane16_swap_b32 v248, v254
    v_add_f32 v248, v248, v254
    v_rcp_f32 v248, v248
    s_mov_b32 s46, 6144
    s_mov_b32 s47, 9216
    v_mul_f32 v48, v48, v248
    v_mul_f32 v49, v49, v248
    v_mul_f32 v50, v50, v248
    v_mul_f32 v51, v51, v248
    v_cvt_pk_bf16_f32 v220, v48, v49
    v_cvt_pk_bf16_f32 v221, v50, v51
    v_mul_f32 v52, v52, v248
    v_mul_f32 v53, v53, v248
    v_mul_f32 v54, v54, v248
    v_mul_f32 v55, v55, v248
    v_cvt_pk_bf16_f32 v222, v52, v53
    v_cvt_pk_bf16_f32 v223, v54, v55
    v_mul_f32 v56, v56, v248
    v_mul_f32 v57, v57, v248
    v_mul_f32 v58, v58, v248
    v_mul_f32 v59, v59, v248
    v_cvt_pk_bf16_f32 v224, v56, v57
    v_cvt_pk_bf16_f32 v225, v58, v59
    v_mul_f32 v60, v60, v248
    v_mul_f32 v61, v61, v248
    v_mul_f32 v62, v62, v248
    v_mul_f32 v63, v63, v248
    v_cvt_pk_bf16_f32 v226, v60, v61
    v_cvt_pk_bf16_f32 v227, v62, v63
    ds_write_b64 v208, v[220:221]
    ds_write_b64 v209, v[222:223]
    ds_write_b64 v210, v[224:225]
    ds_write_b64 v211, v[226:227]
    ds_read_b128 v[232:235], v253 offset:0
    ds_read_b128 v[236:239], v253 offset:1024
    v_mul_f32 v64, v64, v248
    v_mul_f32 v65, v65, v248
    v_mul_f32 v66, v66, v248
    v_mul_f32 v67, v67, v248
    v_cvt_pk_bf16_f32 v220, v64, v65
    v_cvt_pk_bf16_f32 v221, v66, v67
    v_mul_f32 v68, v68, v248
    v_mul_f32 v69, v69, v248
    v_mul_f32 v70, v70, v248
    v_mul_f32 v71, v71, v248
    v_cvt_pk_bf16_f32 v222, v68, v69
    v_cvt_pk_bf16_f32 v223, v70, v71
    v_mul_f32 v72, v72, v248
    v_mul_f32 v73, v73, v248
    v_mul_f32 v74, v74, v248
    v_mul_f32 v75, v75, v248
    v_cvt_pk_bf16_f32 v224, v72, v73
    v_cvt_pk_bf16_f32 v225, v74, v75
    v_mul_f32 v76, v76, v248
    v_mul_f32 v77, v77, v248
    v_mul_f32 v78, v78, v248
    v_mul_f32 v79, v79, v248
    v_cvt_pk_bf16_f32 v226, v76, v77
    v_cvt_pk_bf16_f32 v227, v78, v79
    ds_write_b64 v208, v[220:221]
    ds_write_b64 v209, v[222:223]
    ds_write_b64 v210, v[224:225]
    ds_write_b64 v211, v[226:227]
    ds_read_b128 v[240:243], v253 offset:0
    ds_read_b128 v[228:231], v253 offset:1024
    s_waitcnt lgkmcnt(6)
    buffer_store_dwordx4 v[232:235], v212, s[16:19], s46 offen offset:0 sc1
    buffer_store_dwordx4 v[236:239], v212, s[16:19], s47 offen offset:0 sc1
    v_mul_f32 v80, v80, v248
    v_mul_f32 v81, v81, v248
    v_mul_f32 v82, v82, v248
    v_mul_f32 v83, v83, v248
    v_cvt_pk_bf16_f32 v220, v80, v81
    v_cvt_pk_bf16_f32 v221, v82, v83
    v_mul_f32 v84, v84, v248
    v_mul_f32 v85, v85, v248
    v_mul_f32 v86, v86, v248
    v_mul_f32 v87, v87, v248
    v_cvt_pk_bf16_f32 v222, v84, v85
    v_cvt_pk_bf16_f32 v223, v86, v87
    v_mul_f32 v88, v88, v248
    v_mul_f32 v89, v89, v248
    v_mul_f32 v90, v90, v248
    v_mul_f32 v91, v91, v248
    v_cvt_pk_bf16_f32 v224, v88, v89
    v_cvt_pk_bf16_f32 v225, v90, v91
    v_mul_f32 v92, v92, v248
    v_mul_f32 v93, v93, v248
    v_mul_f32 v94, v94, v248
    v_mul_f32 v95, v95, v248
    v_cvt_pk_bf16_f32 v226, v92, v93
    v_cvt_pk_bf16_f32 v227, v94, v95
    ds_write_b64 v208, v[220:221]
    ds_write_b64 v209, v[222:223]
    ds_write_b64 v210, v[224:225]
    ds_write_b64 v211, v[226:227]
    ds_read_b128 v[232:235], v253 offset:0
    ds_read_b128 v[236:239], v253 offset:1024
    s_waitcnt lgkmcnt(6)
    buffer_store_dwordx4 v[240:243], v212, s[16:19], s46 offen offset:128 sc1
    buffer_store_dwordx4 v[228:231], v212, s[16:19], s47 offen offset:128 sc1
    s_waitcnt lgkmcnt(0)
    buffer_store_dwordx4 v[232:235], v212, s[16:19], s46 offen offset:256 sc1
    buffer_store_dwordx4 v[236:239], v212, s[16:19], s47 offen offset:256 sc1
    s_barrier
    s_barrier
    v_mov_b32 v254, v249
    s_nop 1
    v_permlane32_swap_b32 v249, v254
    v_add_f32 v249, v249, v254
    v_mov_b32 v254, v249
    s_nop 1
    v_permlane16_swap_b32 v249, v254
    v_add_f32 v249, v249, v254
    v_rcp_f32 v249, v249
    s_mov_b32 s46, 12288
    s_mov_b32 s47, 15360
    v_mul_f32 v96, v96, v249
    v_mul_f32 v97, v97, v249
    v_mul_f32 v98, v98, v249
    v_mul_f32 v99, v99, v249
    v_cvt_pk_bf16_f32 v220, v96, v97
    v_cvt_pk_bf16_f32 v221, v98, v99
    v_mul_f32 v100, v100, v249
    v_mul_f32 v101, v101, v249
    v_mul_f32 v102, v102, v249
    v_mul_f32 v103, v103, v249
    v_cvt_pk_bf16_f32 v222, v100, v101
    v_cvt_pk_bf16_f32 v223, v102, v103
    v_mul_f32 v104, v104, v249
    v_mul_f32 v105, v105, v249
    v_mul_f32 v106, v106, v249
    v_mul_f32 v107, v107, v249
    v_cvt_pk_bf16_f32 v224, v104, v105
    v_cvt_pk_bf16_f32 v225, v106, v107
    v_mul_f32 v108, v108, v249
    v_mul_f32 v109, v109, v249
    v_mul_f32 v110, v110, v249
    v_mul_f32 v111, v111, v249
    v_cvt_pk_bf16_f32 v226, v108, v109
    v_cvt_pk_bf16_f32 v227, v110, v111
    ds_write_b64 v208, v[220:221]
    ds_write_b64 v209, v[222:223]
    ds_write_b64 v210, v[224:225]
    ds_write_b64 v211, v[226:227]
    ds_read_b128 v[232:235], v253 offset:0
    ds_read_b128 v[236:239], v253 offset:1024
    v_mul_f32 v112, v112, v249
    v_mul_f32 v113, v113, v249
    v_mul_f32 v114, v114, v249
    v_mul_f32 v115, v115, v249
    v_cvt_pk_bf16_f32 v220, v112, v113
    v_cvt_pk_bf16_f32 v221, v114, v115
    v_mul_f32 v116, v116, v249
    v_mul_f32 v117, v117, v249
    v_mul_f32 v118, v118, v249
    v_mul_f32 v119, v119, v249
    v_cvt_pk_bf16_f32 v222, v116, v117
    v_cvt_pk_bf16_f32 v223, v118, v119
    v_mul_f32 v120, v120, v249
    v_mul_f32 v121, v121, v249
    v_mul_f32 v122, v122, v249
    v_mul_f32 v123, v123, v249
    v_cvt_pk_bf16_f32 v224, v120, v121
    v_cvt_pk_bf16_f32 v225, v122, v123
    v_mul_f32 v124, v124, v249
    v_mul_f32 v125, v125, v249
    v_mul_f32 v126, v126, v249
    v_mul_f32 v127, v127, v249
    v_cvt_pk_bf16_f32 v226, v124, v125
    v_cvt_pk_bf16_f32 v227, v126, v127
    ds_write_b64 v208, v[220:221]
    ds_write_b64 v209, v[222:223]
    ds_write_b64 v210, v[224:225]
    ds_write_b64 v211, v[226:227]
    ds_read_b128 v[240:243], v253 offset:0
    ds_read_b128 v[228:231], v253 offset:1024
    s_waitcnt lgkmcnt(6)
    buffer_store_dwordx4 v[232:235], v212, s[16:19], s46 offen offset:0 sc1
    buffer_store_dwordx4 v[236:239], v212, s[16:19], s47 offen offset:0 sc1
    v_mul_f32 v128, v128, v249
    v_mul_f32 v129, v129, v249
    v_mul_f32 v130, v130, v249
    v_mul_f32 v131, v131, v249
    v_cvt_pk_bf16_f32 v220, v128, v129
    v_cvt_pk_bf16_f32 v221, v130, v131
    v_mul_f32 v132, v132, v249
    v_mul_f32 v133, v133, v249
    v_mul_f32 v134, v134, v249
    v_mul_f32 v135, v135, v249
    v_cvt_pk_bf16_f32 v222, v132, v133
    v_cvt_pk_bf16_f32 v223, v134, v135
    v_mul_f32 v136, v136, v249
    v_mul_f32 v137, v137, v249
    v_mul_f32 v138, v138, v249
    v_mul_f32 v139, v139, v249
    v_cvt_pk_bf16_f32 v224, v136, v137
    v_cvt_pk_bf16_f32 v225, v138, v139
    v_mul_f32 v140, v140, v249
    v_mul_f32 v141, v141, v249
    v_mul_f32 v142, v142, v249
    v_mul_f32 v143, v143, v249
    v_cvt_pk_bf16_f32 v226, v140, v141
    v_cvt_pk_bf16_f32 v227, v142, v143
    ds_write_b64 v208, v[220:221]
    ds_write_b64 v209, v[222:223]
    ds_write_b64 v210, v[224:225]
    ds_write_b64 v211, v[226:227]
    ds_read_b128 v[232:235], v253 offset:0
    ds_read_b128 v[236:239], v253 offset:1024
    s_waitcnt lgkmcnt(6)
    buffer_store_dwordx4 v[240:243], v212, s[16:19], s46 offen offset:128 sc1
    buffer_store_dwordx4 v[228:231], v212, s[16:19], s47 offen offset:128 sc1
    s_waitcnt lgkmcnt(0)
    buffer_store_dwordx4 v[232:235], v212, s[16:19], s46 offen offset:256 sc1
    buffer_store_dwordx4 v[236:239], v212, s[16:19], s47 offen offset:256 sc1
    s_branch L_fin_done
L_fin_b:
    v_mbcnt_lo_u32_b32 v216, -1, 0
    v_mbcnt_hi_u32_b32 v216, -1, v216
    v_and_b32 v215, 15, v216
    v_lshrrev_b32 v216, 4, v216
    v_lshrrev_b32 v213, 1, v216
    v_and_b32 v214, 7, v215
    v_xor_b32 v213, v213, v214
    v_lshlrev_b32 v213, 4, v213
    v_and_b32 v214, 1, v216
    v_lshl_add_u32 v213, v214, 3, v213
    v_lshl_add_u32 v213, v215, 7, v213
    v_add_u32 v208, s37, v213
    v_xor_b32 v209, 32, v208
    v_xor_b32 v210, 64, v208
    v_xor_b32 v211, 96, v208
    v_lshl_add_u32 v213, v216, 4, v215
    v_lshrrev_b32 v214, 3, v213
    v_xor_b32 v213, v213, v214
    v_and_b32 v213, 7, v213
    v_lshlrev_b32 v213, 4, v213
    v_add_u32 v214, s36, v214
    v_mul_u32_u24 v214, 384, v214
    v_add_u32 v212, v213, v214
    v_mov_b32 v254, v247
    s_nop 1
    v_permlane32_swap_b32 v247, v254
    v_add_f32 v247, v247, v254
    v_mov_b32 v254, v247
    s_nop 1
    v_permlane16_swap_b32 v247, v254
    v_add_f32 v247, v247, v254
    v_rcp_f32 v247, v247
    s_mov_b32 s46, 0
    s_mov_b32 s47, 3072
    v_mul_f32 v0, v0, v247
    v_mul_f32 v1, v1, v247
    v_mul_f32 v2, v2, v247
    v_mul_f32 v3, v3, v247
    v_cvt_pk_bf16_f32 v220, v0, v1
    v_cvt_pk_bf16_f32 v221, v2, v3
    v_mul_f32 v4, v4, v247
    v_mul_f32 v5, v5, v247
    v_mul_f32 v6, v6, v247
    v_mul_f32 v7, v7, v247
    v_cvt_pk_bf16_f32 v222, v4, v5
    v_cvt_pk_bf16_f32 v223, v6, v7
    v_mul_f32 v8, v8, v247
    v_mul_f32 v9, v9, v247
    v_mul_f32 v10, v10, v247
    v_mul_f32 v11, v11, v247
    v_cvt_pk_bf16_f32 v224, v8, v9
    v_cvt_pk_bf16_f32 v225, v10, v11
    v_mul_f32 v12, v12, v247
    v_mul_f32 v13, v13, v247
    v_mul_f32 v14, v14, v247
    v_mul_f32 v15, v15, v247
    v_cvt_pk_bf16_f32 v226, v12, v13
    v_cvt_pk_bf16_f32 v227, v14, v15
    ds_write_b64 v208, v[220:221]
    ds_write_b64 v209, v[222:223]
    ds_write_b64 v210, v[224:225]
    ds_write_b64 v211, v[226:227]
    ds_read_b128 v[232:235], v253 offset:0
    ds_read_b128 v[236:239], v253 offset:1024
    v_mul_f32 v16, v16, v247
    v_mul_f32 v17, v17, v247
    v_mul_f32 v18, v18, v247
    v_mul_f32 v19, v19, v247
    v_cvt_pk_bf16_f32 v220, v16, v17
    v_cvt_pk_bf16_f32 v221, v18, v19
    v_mul_f32 v20, v20, v247
    v_mul_f32 v21, v21, v247
    v_mul_f32 v22, v22, v247
    v_mul_f32 v23, v23, v247
    v_cvt_pk_bf16_f32 v222, v20, v21
    v_cvt_pk_bf16_f32 v223, v22, v23
    v_mul_f32 v24, v24, v247
    v_mul_f32 v25, v25, v247
    v_mul_f32 v26, v26, v247
    v_mul_f32 v27, v27, v247
    v_cvt_pk_bf16_f32 v224, v24, v25
    v_cvt_pk_bf16_f32 v225, v26, v27
    v_mul_f32 v28, v28, v247
    v_mul_f32 v29, v29, v247
    v_mul_f32 v30, v30, v247
    v_mul_f32 v31, v31, v247
    v_cvt_pk_bf16_f32 v226, v28, v29
    v_cvt_pk_bf16_f32 v227, v30, v31
    ds_write_b64 v208, v[220:221]
    ds_write_b64 v209, v[222:223]
    ds_write_b64 v210, v[224:225]
    ds_write_b64 v211, v[226:227]
    ds_read_b128 v[240:243], v253 offset:0
    ds_read_b128 v[228:231], v253 offset:1024
    s_waitcnt lgkmcnt(6)
    buffer_store_dwordx4 v[232:235], v212, s[16:19], s46 offen offset:0 sc1
    buffer_store_dwordx4 v[236:239], v212, s[16:19], s47 offen offset:0 sc1
    v_mul_f32 v32, v32, v247
    v_mul_f32 v33, v33, v247
    v_mul_f32 v34, v34, v247
    v_mul_f32 v35, v35, v247
    v_cvt_pk_bf16_f32 v220, v32, v33
    v_cvt_pk_bf16_f32 v221, v34, v35
    v_mul_f32 v36, v36, v247
    v_mul_f32 v37, v37, v247
    v_mul_f32 v38, v38, v247
    v_mul_f32 v39, v39, v247
    v_cvt_pk_bf16_f32 v222, v36, v37
    v_cvt_pk_bf16_f32 v223, v38, v39
    v_mul_f32 v40, v40, v247
    v_mul_f32 v41, v41, v247
    v_mul_f32 v42, v42, v247
    v_mul_f32 v43, v43, v247
    v_cvt_pk_bf16_f32 v224, v40, v41
    v_cvt_pk_bf16_f32 v225, v42, v43
    v_mul_f32 v44, v44, v247
    v_mul_f32 v45, v45, v247
    v_mul_f32 v46, v46, v247
    v_mul_f32 v47, v47, v247
    v_cvt_pk_bf16_f32 v226, v44, v45
    v_cvt_pk_bf16_f32 v227, v46, v47
    ds_write_b64 v208, v[220:221]
    ds_write_b64 v209, v[222:223]
    ds_write_b64 v210, v[224:225]
    ds_write_b64 v211, v[226:227]
    ds_read_b128 v[232:235], v253 offset:0
    ds_read_b128 v[236:239], v253 offset:1024
    s_waitcnt lgkmcnt(6)
    buffer_store_dwordx4 v[240:243], v212, s[16:19], s46 offen offset:128 sc1
    buffer_store_dwordx4 v[228:231], v212, s[16:19], s47 offen offset:128 sc1
    s_waitcnt lgkmcnt(0)
    buffer_store_dwordx4 v[232:235], v212, s[16:19], s46 offen offset:256 sc1
    buffer_store_dwordx4 v[236:239], v212, s[16:19], s47 offen offset:256 sc1
    v_mov_b32 v254, v248
    s_nop 1
    v_permlane32_swap_b32 v248, v254
    v_add_f32 v248, v248, v254
    v_mov_b32 v254, v248
    s_nop 1
    v_permlane16_swap_b32 v248, v254
    v_add_f32 v248, v248, v254
    v_rcp_f32 v248, v248
    s_mov_b32 s46, 6144
    s_mov_b32 s47, 9216
    v_mul_f32 v48, v48, v248
    v_mul_f32 v49, v49, v248
    v_mul_f32 v50, v50, v248
    v_mul_f32 v51, v51, v248
    v_cvt_pk_bf16_f32 v220, v48, v49
    v_cvt_pk_bf16_f32 v221, v50, v51
    v_mul_f32 v52, v52, v248
    v_mul_f32 v53, v53, v248
    v_mul_f32 v54, v54, v248
    v_mul_f32 v55, v55, v248
    v_cvt_pk_bf16_f32 v222, v52, v53
    v_cvt_pk_bf16_f32 v223, v54, v55
    v_mul_f32 v56, v56, v248
    v_mul_f32 v57, v57, v248
    v_mul_f32 v58, v58, v248
    v_mul_f32 v59, v59, v248
    v_cvt_pk_bf16_f32 v224, v56, v57
    v_cvt_pk_bf16_f32 v225, v58, v59
    v_mul_f32 v60, v60, v248
    v_mul_f32 v61, v61, v248
    v_mul_f32 v62, v62, v248
    v_mul_f32 v63, v63, v248
    v_cvt_pk_bf16_f32 v226, v60, v61
    v_cvt_pk_bf16_f32 v227, v62, v63
    ds_write_b64 v208, v[220:221]
    ds_write_b64 v209, v[222:223]
    ds_write_b64 v210, v[224:225]
    ds_write_b64 v211, v[226:227]
    ds_read_b128 v[232:235], v253 offset:0
    ds_read_b128 v[236:239], v253 offset:1024
    v_mul_f32 v64, v64, v248
    v_mul_f32 v65, v65, v248
    v_mul_f32 v66, v66, v248
    v_mul_f32 v67, v67, v248
    v_cvt_pk_bf16_f32 v220, v64, v65
    v_cvt_pk_bf16_f32 v221, v66, v67
    v_mul_f32 v68, v68, v248
    v_mul_f32 v69, v69, v248
    v_mul_f32 v70, v70, v248
    v_mul_f32 v71, v71, v248
    v_cvt_pk_bf16_f32 v222, v68, v69
    v_cvt_pk_bf16_f32 v223, v70, v71
    v_mul_f32 v72, v72, v248
    v_mul_f32 v73, v73, v248
    v_mul_f32 v74, v74, v248
    v_mul_f32 v75, v75, v248
    v_cvt_pk_bf16_f32 v224, v72, v73
    v_cvt_pk_bf16_f32 v225, v74, v75
    v_mul_f32 v76, v76, v248
    v_mul_f32 v77, v77, v248
    v_mul_f32 v78, v78, v248
    v_mul_f32 v79, v79, v248
    v_cvt_pk_bf16_f32 v226, v76, v77
    v_cvt_pk_bf16_f32 v227, v78, v79
    ds_write_b64 v208, v[220:221]
    ds_write_b64 v209, v[222:223]
    ds_write_b64 v210, v[224:225]
    ds_write_b64 v211, v[226:227]
    ds_read_b128 v[240:243], v253 offset:0
    ds_read_b128 v[228:231], v253 offset:1024
    s_waitcnt lgkmcnt(6)
    buffer_store_dwordx4 v[232:235], v212, s[16:19], s46 offen offset:0 sc1
    buffer_store_dwordx4 v[236:239], v212, s[16:19], s47 offen offset:0 sc1
    v_mul_f32 v80, v80, v248
    v_mul_f32 v81, v81, v248
    v_mul_f32 v82, v82, v248
    v_mul_f32 v83, v83, v248
    v_cvt_pk_bf16_f32 v220, v80, v81
    v_cvt_pk_bf16_f32 v221, v82, v83
    v_mul_f32 v84, v84, v248
    v_mul_f32 v85, v85, v248
    v_mul_f32 v86, v86, v248
    v_mul_f32 v87, v87, v248
    v_cvt_pk_bf16_f32 v222, v84, v85
    v_cvt_pk_bf16_f32 v223, v86, v87
    v_mul_f32 v88, v88, v248
    v_mul_f32 v89, v89, v248
    v_mul_f32 v90, v90, v248
    v_mul_f32 v91, v91, v248
    v_cvt_pk_bf16_f32 v224, v88, v89
    v_cvt_pk_bf16_f32 v225, v90, v91
    v_mul_f32 v92, v92, v248
    v_mul_f32 v93, v93, v248
    v_mul_f32 v94, v94, v248
    v_mul_f32 v95, v95, v248
    v_cvt_pk_bf16_f32 v226, v92, v93
    v_cvt_pk_bf16_f32 v227, v94, v95
    ds_write_b64 v208, v[220:221]
    ds_write_b64 v209, v[222:223]
    ds_write_b64 v210, v[224:225]
    ds_write_b64 v211, v[226:227]
    ds_read_b128 v[232:235], v253 offset:0
    ds_read_b128 v[236:239], v253 offset:1024
    s_waitcnt lgkmcnt(6)
    buffer_store_dwordx4 v[240:243], v212, s[16:19], s46 offen offset:128 sc1
    buffer_store_dwordx4 v[228:231], v212, s[16:19], s47 offen offset:128 sc1
    s_waitcnt lgkmcnt(0)
    buffer_store_dwordx4 v[232:235], v212, s[16:19], s46 offen offset:256 sc1
    buffer_store_dwordx4 v[236:239], v212, s[16:19], s47 offen offset:256 sc1
    v_mov_b32 v254, v249
    s_nop 1
    v_permlane32_swap_b32 v249, v254
    v_add_f32 v249, v249, v254
    v_mov_b32 v254, v249
    s_nop 1
    v_permlane16_swap_b32 v249, v254
    v_add_f32 v249, v249, v254
    v_rcp_f32 v249, v249
    s_mov_b32 s46, 12288
    s_mov_b32 s47, 15360
    v_mul_f32 v96, v96, v249
    v_mul_f32 v97, v97, v249
    v_mul_f32 v98, v98, v249
    v_mul_f32 v99, v99, v249
    v_cvt_pk_bf16_f32 v220, v96, v97
    v_cvt_pk_bf16_f32 v221, v98, v99
    v_mul_f32 v100, v100, v249
    v_mul_f32 v101, v101, v249
    v_mul_f32 v102, v102, v249
    v_mul_f32 v103, v103, v249
    v_cvt_pk_bf16_f32 v222, v100, v101
    v_cvt_pk_bf16_f32 v223, v102, v103
    v_mul_f32 v104, v104, v249
    v_mul_f32 v105, v105, v249
    v_mul_f32 v106, v106, v249
    v_mul_f32 v107, v107, v249
    v_cvt_pk_bf16_f32 v224, v104, v105
    v_cvt_pk_bf16_f32 v225, v106, v107
    v_mul_f32 v108, v108, v249
    v_mul_f32 v109, v109, v249
    v_mul_f32 v110, v110, v249
    v_mul_f32 v111, v111, v249
    v_cvt_pk_bf16_f32 v226, v108, v109
    v_cvt_pk_bf16_f32 v227, v110, v111
    ds_write_b64 v208, v[220:221]
    ds_write_b64 v209, v[222:223]
    ds_write_b64 v210, v[224:225]
    ds_write_b64 v211, v[226:227]
    ds_read_b128 v[232:235], v253 offset:0
    ds_read_b128 v[236:239], v253 offset:1024
    v_mul_f32 v112, v112, v249
    v_mul_f32 v113, v113, v249
    v_mul_f32 v114, v114, v249
    v_mul_f32 v115, v115, v249
    v_cvt_pk_bf16_f32 v220, v112, v113
    v_cvt_pk_bf16_f32 v221, v114, v115
    v_mul_f32 v116, v116, v249
    v_mul_f32 v117, v117, v249
    v_mul_f32 v118, v118, v249
    v_mul_f32 v119, v119, v249
    v_cvt_pk_bf16_f32 v222, v116, v117
    v_cvt_pk_bf16_f32 v223, v118, v119
    v_mul_f32 v120, v120, v249
    v_mul_f32 v121, v121, v249
    v_mul_f32 v122, v122, v249
    v_mul_f32 v123, v123, v249
    v_cvt_pk_bf16_f32 v224, v120, v121
    v_cvt_pk_bf16_f32 v225, v122, v123
    v_mul_f32 v124, v124, v249
    v_mul_f32 v125, v125, v249
    v_mul_f32 v126, v126, v249
    v_mul_f32 v127, v127, v249
    v_cvt_pk_bf16_f32 v226, v124, v125
    v_cvt_pk_bf16_f32 v227, v126, v127
    ds_write_b64 v208, v[220:221]
    ds_write_b64 v209, v[222:223]
    ds_write_b64 v210, v[224:225]
    ds_write_b64 v211, v[226:227]
    ds_read_b128 v[240:243], v253 offset:0
    ds_read_b128 v[228:231], v253 offset:1024
    s_waitcnt lgkmcnt(6)
    buffer_store_dwordx4 v[232:235], v212, s[16:19], s46 offen offset:0 sc1
    buffer_store_dwordx4 v[236:239], v212, s[16:19], s47 offen offset:0 sc1
    v_mul_f32 v128, v128, v249
    v_mul_f32 v129, v129, v249
    v_mul_f32 v130, v130, v249
    v_mul_f32 v131, v131, v249
    v_cvt_pk_bf16_f32 v220, v128, v129
    v_cvt_pk_bf16_f32 v221, v130, v131
    v_mul_f32 v132, v132, v249
    v_mul_f32 v133, v133, v249
    v_mul_f32 v134, v134, v249
    v_mul_f32 v135, v135, v249
    v_cvt_pk_bf16_f32 v222, v132, v133
    v_cvt_pk_bf16_f32 v223, v134, v135
    v_mul_f32 v136, v136, v249
    v_mul_f32 v137, v137, v249
    v_mul_f32 v138, v138, v249
    v_mul_f32 v139, v139, v249
    v_cvt_pk_bf16_f32 v224, v136, v137
    v_cvt_pk_bf16_f32 v225, v138, v139
    v_mul_f32 v140, v140, v249
    v_mul_f32 v141, v141, v249
    v_mul_f32 v142, v142, v249
    v_mul_f32 v143, v143, v249
    v_cvt_pk_bf16_f32 v226, v140, v141
    v_cvt_pk_bf16_f32 v227, v142, v143
    ds_write_b64 v208, v[220:221]
    ds_write_b64 v209, v[222:223]
    ds_write_b64 v210, v[224:225]
    ds_write_b64 v211, v[226:227]
    ds_read_b128 v[232:235], v253 offset:0
    ds_read_b128 v[236:239], v253 offset:1024
    s_waitcnt lgkmcnt(6)
    buffer_store_dwordx4 v[240:243], v212, s[16:19], s46 offen offset:128 sc1
    buffer_store_dwordx4 v[228:231], v212, s[16:19], s47 offen offset:128 sc1
    s_waitcnt lgkmcnt(0)
    buffer_store_dwordx4 v[232:235], v212, s[16:19], s46 offen offset:256 sc1
    buffer_store_dwordx4 v[236:239], v212, s[16:19], s47 offen offset:256 sc1
L_fin_done:
L_end:
    s_endpgm
L_rare:
    s_waitcnt lgkmcnt(0)
    s_nop 3
    v_mbcnt_lo_u32_b32 v255, -1, 0
    v_mbcnt_hi_u32_b32 v255, -1, v255
    v_and_b32 v254, 15, v255
    v_lshrrev_b32 v255, 4, v255
    v_mul_u32_u24 v254, 384, v254
    v_lshlrev_b32 v255, 4, v255
    v_add_u32 v254, v254, v255
    s_mul_i32 s46, s29, 12288
    s_add_u32 s47, s46, 6144
    buffer_load_dwordx4 v[232:235], v254, s[12:15], s46 offen offset:0
    buffer_load_dwordx4 v[236:239], v254, s[12:15], s46 offen offset:64
    buffer_load_dwordx4 v[240:243], v254, s[12:15], s46 offen offset:128
    buffer_load_dwordx4 v[220:223], v254, s[12:15], s46 offen offset:192
    buffer_load_dwordx4 v[224:227], v254, s[12:15], s46 offen offset:256
    buffer_load_dwordx4 v[228:231], v254, s[12:15], s46 offen offset:320
    s_waitcnt vmcnt(0)
    v_mfma_f32_16x16x32_bf16 v[208:211], v[232:235], v[144:147], 0
    v_mfma_f32_16x16x32_bf16 v[212:215], v[232:235], v[168:171], 0
    v_mfma_f32_16x16x32_bf16 v[216:219], v[232:235], v[192:195], 0
    v_mfma_f32_16x16x32_bf16 v[208:211], v[236:239], v[148:151], v[208:211]
    v_mfma_f32_16x16x32_bf16 v[212:215], v[236:239], v[172:175], v[212:215]
    v_mfma_f32_16x16x32_bf16 v[216:219], v[236:239], v[196:199], v[216:219]
    v_mfma_f32_16x16x32_bf16 v[208:211], v[240:243], v[152:155], v[208:211]
    v_mfma_f32_16x16x32_bf16 v[212:215], v[240:243], v[176:179], v[212:215]
    v_mfma_f32_16x16x32_bf16 v[216:219], v[240:243], v[200:203], v[216:219]
    v_mfma_f32_16x16x32_bf16 v[208:211], v[220:223], v[156:159], v[208:211]
    v_mfma_f32_16x16x32_bf16 v[212:215], v[220:223], v[180:183], v[212:215]
    v_mfma_f32_16x16x32_bf16 v[216:219], v[220:223], v[204:207], v[216:219]
    ds_read_b128 v[232:235], v253 offset:0
    ds_read_b128 v[236:239], v253 offset:1024
    s_waitcnt lgkmcnt(0)
    v_mfma_f32_16x16x32_bf16 v[208:211], v[224:227], v[160:163], v[208:211]
    v_mfma_f32_16x16x32_bf16 v[212:215], v[224:227], v[184:187], v[212:215]
    v_mfma_f32_16x16x32_bf16 v[216:219], v[224:227], v[232:235], v[216:219]
    v_mfma_f32_16x16x32_bf16 v[208:211], v[228:231], v[164:167], v[208:211]
    v_mfma_f32_16x16x32_bf16 v[212:215], v[228:231], v[188:191], v[212:215]
    v_mfma_f32_16x16x32_bf16 v[216:219], v[228:231], v[236:239], v[216:219]
    buffer_load_dwordx4 v[232:235], v254, s[12:15], s47 offen offset:0
    buffer_load_dwordx4 v[236:239], v254, s[12:15], s47 offen offset:64
    buffer_load_dwordx4 v[240:243], v254, s[12:15], s47 offen offset:128
    s_waitcnt vmcnt(0)
    v_mfma_f32_16x16x32_bf16 v[220:223], v[232:235], v[144:147], 0
    v_mfma_f32_16x16x32_bf16 v[224:227], v[232:235], v[168:171], 0
    v_mfma_f32_16x16x32_bf16 v[228:231], v[232:235], v[192:195], 0
    v_mfma_f32_16x16x32_bf16 v[220:223], v[236:239], v[148:151], v[220:223]
    v_mfma_f32_16x16x32_bf16 v[224:227], v[236:239], v[172:175], v[224:227]
    v_mfma_f32_16x16x32_bf16 v[228:231], v[236:239], v[196:199], v[228:231]
    v_mfma_f32_16x16x32_bf16 v[220:223], v[240:243], v[152:155], v[220:223]
    v_mfma_f32_16x16x32_bf16 v[224:227], v[240:243], v[176:179], v[224:227]
    v_mfma_f32_16x16x32_bf16 v[228:231], v[240:243], v[200:203], v[228:231]
    buffer_load_dwordx4 v[232:235], v254, s[12:15], s47 offen offset:192
    buffer_load_dwordx4 v[236:239], v254, s[12:15], s47 offen offset:256
    ds_read_b128 v[240:243], v253 offset:0
    s_waitcnt vmcnt(0)
    s_waitcnt lgkmcnt(0)
    v_mfma_f32_16x16x32_bf16 v[220:223], v[232:235], v[156:159], v[220:223]
    v_mfma_f32_16x16x32_bf16 v[224:227], v[232:235], v[180:183], v[224:227]
    v_mfma_f32_16x16x32_bf16 v[228:231], v[232:235], v[204:207], v[228:231]
    v_mfma_f32_16x16x32_bf16 v[220:223], v[236:239], v[160:163], v[220:223]
    v_mfma_f32_16x16x32_bf16 v[224:227], v[236:239], v[184:187], v[224:227]
    v_mfma_f32_16x16x32_bf16 v[228:231], v[236:239], v[240:243], v[228:231]
    buffer_load_dwordx4 v[232:235], v254, s[12:15], s47 offen offset:320
    ds_read_b128 v[236:239], v253 offset:1024
    s_waitcnt vmcnt(0)
    s_waitcnt lgkmcnt(0)
    v_mfma_f32_16x16x32_bf16 v[220:223], v[232:235], v[164:167], v[220:223]
    v_mfma_f32_16x16x32_bf16 v[224:227], v[232:235], v[188:191], v[224:227]
    v_mfma_f32_16x16x32_bf16 v[228:231], v[232:235], v[236:239], v[228:231]
    s_branch L_common
L_slow:
    ds_read_b128 v[232:235], v250 offset:0
    ds_read_b128 v[236:239], v250 offset:1024
    ds_read_b128 v[240:243], v250 offset:2048
    ds_read_b128 v[220:223], v253 offset:0
    v_xor_b32 v250, 64, v250
    ds_read_b128 v[224:227], v250 offset:0
    ds_read_b128 v[228:231], v250 offset:1024
    s_waitcnt lgkmcnt(5)
    v_mfma_f32_16x16x32_bf16 v[208:211], v[232:235], v[144:147], 0
    s_add_u32 s33, s32, 24576
    s_cmp_eq_u32 s33, 147456
    v_mfma_f32_16x16x32_bf16 v[212:215], v[232:235], v[168:171], 0
    s_cselect_b32 s33, 0, s33
    s_sub_u32 s34, s33, s32
    v_mfma_f32_16x16x32_bf16 v[216:219], v[232:235], v[192:195], 0
    s_mov_b32 s32, s33
    s_waitcnt lgkmcnt(4)
    v_mfma_f32_16x16x32_bf16 v[208:211], v[236:239], v[152:155], v[208:211]
    ds_read_b128 v[232:235], v250 offset:2048
    v_mfma_f32_16x16x32_bf16 v[212:215], v[236:239], v[176:179], v[212:215]
    s_add_u32 s35, s31, s27
    s_add_u32 s50, s29, s42
    v_mfma_f32_16x16x32_bf16 v[216:219], v[236:239], v[200:203], v[216:219]
    s_mul_i32 s33, s50, 24576
    s_waitcnt lgkmcnt(3)
    v_mfma_f32_16x16x32_bf16 v[208:211], v[240:243], v[160:163], v[208:211]
    ds_read_b128 v[236:239], v253 offset:1024
    v_mfma_f32_16x16x32_bf16 v[212:215], v[240:243], v[184:187], v[212:215]
    s_add_u32 s33, s33, s44
    s_cmp_lt_u32 s50, s43
    v_mfma_f32_16x16x32_bf16 v[216:219], v[240:243], v[220:223], v[216:219]
    s_cselect_b32 s45, s33, s30
    s_waitcnt lgkmcnt(3)
    v_mfma_f32_16x16x32_bf16 v[208:211], v[224:227], v[148:151], v[208:211]
    ds_read_b128 v[240:243], v250 offset:8192
    v_mfma_f32_16x16x32_bf16 v[212:215], v[224:227], v[172:175], v[212:215]
    s_cselect_b32 s8, s40, s38
    s_cselect_b32 s9, s41, s39
    v_mfma_f32_16x16x32_bf16 v[216:219], v[224:227], v[196:199], v[216:219]
    s_cselect_b32 s10, s3, s100
    s_waitcnt lgkmcnt(1)
    v_mfma_f32_16x16x32_bf16 v[208:211], v[232:235], v[164:167], v[208:211]
    s_add_u32 s30, s30, 12288
    s_add_u32 s31, s31, 24576
    v_mfma_f32_16x16x32_bf16 v[212:215], v[232:235], v[188:191], v[212:215]
    s_cmp_eq_u32 s31, 147456
    s_cselect_b32 s31, 0, s31
    v_mfma_f32_16x16x32_bf16 v[216:219], v[232:235], v[236:239], v[216:219]
    v_mfma_f32_16x16x32_bf16 v[208:211], v[228:231], v[156:159], v[208:211]
    ds_read_b128 v[232:235], v250 offset:6144
    v_mfma_f32_16x16x32_bf16 v[212:215], v[228:231], v[180:183], v[212:215]
    v_mfma_f32_16x16x32_bf16 v[216:219], v[228:231], v[204:207], v[216:219]
    s_waitcnt lgkmcnt(1)
    v_mfma_f32_16x16x32_bf16 v[220:223], v[240:243], v[164:167], 0
    v_mfma_f32_16x16x32_bf16 v[224:227], v[240:243], v[188:191], 0
    v_mfma_f32_16x16x32_bf16 v[228:231], v[240:243], v[236:239], 0
    ds_read_b128 v[240:243], v250 offset:7168
    s_waitcnt lgkmcnt(1)
    v_mfma_f32_16x16x32_bf16 v[220:223], v[232:235], v[148:151], v[220:223]
    v_xor_b32 v250, 64, v250
    v_mfma_f32_16x16x32_bf16 v[224:227], v[232:235], v[172:175], v[224:227]
    ds_read_b128 v[236:239], v250 offset:6144
    v_mfma_f32_16x16x32_bf16 v[228:231], v[232:235], v[196:199], v[228:231]
    s_waitcnt lgkmcnt(1)
    v_mfma_f32_16x16x32_bf16 v[220:223], v[240:243], v[156:159], v[220:223]
    ds_read_b128 v[232:235], v250 offset:7168
    v_mfma_f32_16x16x32_bf16 v[224:227], v[240:243], v[180:183], v[224:227]
    v_mfma_f32_16x16x32_bf16 v[228:231], v[240:243], v[204:207], v[228:231]
    s_waitcnt lgkmcnt(1)
    v_mfma_f32_16x16x32_bf16 v[220:223], v[236:239], v[144:147], v[220:223]
    ds_read_b128 v[240:243], v250 offset:8192
    v_mfma_f32_16x16x32_bf16 v[224:227], v[236:239], v[168:171], v[224:227]
    v_mfma_f32_16x16x32_bf16 v[228:231], v[236:239], v[192:195], v[228:231]
    s_waitcnt lgkmcnt(1)
    v_mfma_f32_16x16x32_bf16 v[220:223], v[232:235], v[152:155], v[220:223]
    ds_read_b128 v[236:239], v253 offset:0
    v_mfma_f32_16x16x32_bf16 v[224:227], v[232:235], v[176:179], v[224:227]
    v_mfma_f32_16x16x32_bf16 v[228:231], v[232:235], v[200:203], v[228:231]
    s_waitcnt lgkmcnt(0)
    v_mfma_f32_16x16x32_bf16 v[220:223], v[240:243], v[160:163], v[220:223]
    v_mfma_f32_16x16x32_bf16 v[224:227], v[240:243], v[184:187], v[224:227]
    v_mfma_f32_16x16x32_bf16 v[228:231], v[240:243], v[236:239], v[228:231]
    s_setprio 0
L_common:
    s_nop 7
    v_max3_f32 v232, v208, v209, v210
    v_max3_f32 v232, v232, v211, v220
    v_max3_f32 v232, v232, v221, v222
    v_max_f32 v232, v232, v223
    v_max3_f32 v233, v212, v213, v214
    v_max3_f32 v233, v233, v215, v224
    v_max3_f32 v233, v233, v225, v226
    v_max_f32 v233, v233, v227
    v_max3_f32 v234, v216, v217, v218
    v_max3_f32 v234, v234, v219, v228
    v_max3_f32 v234, v234, v229, v230
    v_max_f32 v234, v234, v231
    v_mov_b32 v236, v232
    s_nop 1
    v_permlane32_swap_b32 v232, v236
    v_max_f32 v232, v232, v236
    v_mov_b32 v236, v232
    s_nop 1
    v_permlane16_swap_b32 v232, v236
    v_max_f32 v232, v232, v236
    v_mov_b32 v237, v233
    s_nop 1
    v_permlane32_swap_b32 v233, v237
    v_max_f32 v233, v233, v237
    v_mov_b32 v237, v233
    s_nop 1
    v_permlane16_swap_b32 v233, v237
    v_max_f32 v233, v233, v237
    v_mov_b32 v238, v234
    s_nop 1
    v_permlane32_swap_b32 v234, v238
    v_max_f32 v234, v234, v238
    v_mov_b32 v238, v234
    s_nop 1
    v_permlane16_swap_b32 v234, v238
    v_max_f32 v234, v234, v238
    v_mul_f32 v232, s28, v232
    v_ceil_f32 v232, v232
    v_max_f32 v232, v232, v244
    v_sub_f32 v236, v244, v232
    v_exp_f32 v236, v236
    v_mov_b32 v244, v232
    v_mul_f32 v247, v247, v236
    v_mul_f32 v233, s28, v233
    v_ceil_f32 v233, v233
    v_max_f32 v233, v233, v245
    v_sub_f32 v237, v245, v233
    v_exp_f32 v237, v237
    v_mov_b32 v245, v233
    v_mul_f32 v248, v248, v237
    v_mul_f32 v234, s28, v234
    v_ceil_f32 v234, v234
    v_max_f32 v234, v234, v246
    v_sub_f32 v238, v246, v234
    v_exp_f32 v238, v238
    v_mov_b32 v246, v234
    v_mul_f32 v249, v249, v238
    s_and_b32 s46, s29, 15
    s_cmp_eq_u32 s46, 0
    s_cbranch_scc1 L_norescale
    v_mul_f32 v0, v0, v236
    v_mul_f32 v1, v1, v236
    v_mul_f32 v2, v2, v236
    v_mul_f32 v3, v3, v236
    v_mul_f32 v4, v4, v236
    v_mul_f32 v5, v5, v236
    v_mul_f32 v6, v6, v236
    v_mul_f32 v7, v7, v236
    v_mul_f32 v8, v8, v236
    v_mul_f32 v9, v9, v236
    v_mul_f32 v10, v10, v236
    v_mul_f32 v11, v11, v236
    v_mul_f32 v12, v12, v236
    v_mul_f32 v13, v13, v236
    v_mul_f32 v14, v14, v236
    v_mul_f32 v15, v15, v236
    v_mul_f32 v16, v16, v236
    v_mul_f32 v17, v17, v236
    v_mul_f32 v18, v18, v236
    v_mul_f32 v19, v19, v236
    v_mul_f32 v20, v20, v236
    v_mul_f32 v21, v21, v236
    v_mul_f32 v22, v22, v236
    v_mul_f32 v23, v23, v236
    v_mul_f32 v24, v24, v236
    v_mul_f32 v25, v25, v236
    v_mul_f32 v26, v26, v236
    v_mul_f32 v27, v27, v236
    v_mul_f32 v28, v28, v236
    v_mul_f32 v29, v29, v236
    v_mul_f32 v30, v30, v236
    v_mul_f32 v31, v31, v236
    v_mul_f32 v32, v32, v236
    v_mul_f32 v33, v33, v236
    v_mul_f32 v34, v34, v236
    v_mul_f32 v35, v35, v236
    v_mul_f32 v36, v36, v236
    v_mul_f32 v37, v37, v236
    v_mul_f32 v38, v38, v236
    v_mul_f32 v39, v39, v236
    v_mul_f32 v40, v40, v236
    v_mul_f32 v41, v41, v236
    v_mul_f32 v42, v42, v236
    v_mul_f32 v43, v43, v236
    v_mul_f32 v44, v44, v236
    v_mul_f32 v45, v45, v236
    v_mul_f32 v46, v46, v236
    v_mul_f32 v47, v47, v236
    v_mul_f32 v48, v48, v237
    v_mul_f32 v49, v49, v237
    v_mul_f32 v50, v50, v237
    v_mul_f32 v51, v51, v237
    v_mul_f32 v52, v52, v237
    v_mul_f32 v53, v53, v237
    v_mul_f32 v54, v54, v237
    v_mul_f32 v55, v55, v237
    v_mul_f32 v56, v56, v237
    v_mul_f32 v57, v57, v237
    v_mul_f32 v58, v58, v237
    v_mul_f32 v59, v59, v237
    v_mul_f32 v60, v60, v237
    v_mul_f32 v61, v61, v237
    v_mul_f32 v62, v62, v237
    v_mul_f32 v63, v63, v237
    v_mul_f32 v64, v64, v237
    v_mul_f32 v65, v65, v237
    v_mul_f32 v66, v66, v237
    v_mul_f32 v67, v67, v237
    v_mul_f32 v68, v68, v237
    v_mul_f32 v69, v69, v237
    v_mul_f32 v70, v70, v237
    v_mul_f32 v71, v71, v237
    v_mul_f32 v72, v72, v237
    v_mul_f32 v73, v73, v237
    v_mul_f32 v74, v74, v237
    v_mul_f32 v75, v75, v237
    v_mul_f32 v76, v76, v237
    v_mul_f32 v77, v77, v237
    v_mul_f32 v78, v78, v237
    v_mul_f32 v79, v79, v237
    v_mul_f32 v80, v80, v237
    v_mul_f32 v81, v81, v237
    v_mul_f32 v82, v82, v237
    v_mul_f32 v83, v83, v237
    v_mul_f32 v84, v84, v237
    v_mul_f32 v85, v85, v237
    v_mul_f32 v86, v86, v237
    v_mul_f32 v87, v87, v237
    v_mul_f32 v88, v88, v237
    v_mul_f32 v89, v89, v237
    v_mul_f32 v90, v90, v237
    v_mul_f32 v91, v91, v237
    v_mul_f32 v92, v92, v237
    v_mul_f32 v93, v93, v237
    v_mul_f32 v94, v94, v237
    v_mul_f32 v95, v95, v237
    v_mul_f32 v96, v96, v238
    v_mul_f32 v97, v97, v238
    v_mul_f32 v98, v98, v238
    v_mul_f32 v99, v99, v238
    v_mul_f32 v100, v100, v238
    v_mul_f32 v101, v101, v238
    v_mul_f32 v102, v102, v238
    v_mul_f32 v103, v103, v238
    v_mul_f32 v104, v104, v238
    v_mul_f32 v105, v105, v238
    v_mul_f32 v106, v106, v238
    v_mul_f32 v107, v107, v238
    v_mul_f32 v108, v108, v238
    v_mul_f32 v109, v109, v238
    v_mul_f32 v110, v110, v238
    v_mul_f32 v111, v111, v238
    v_mul_f32 v112, v112, v238
    v_mul_f32 v113, v113, v238
    v_mul_f32 v114, v114, v238
    v_mul_f32 v115, v115, v238
    v_mul_f32 v116, v116, v238
    v_mul_f32 v117, v117, v238
    v_mul_f32 v118, v118, v238
    v_mul_f32 v119, v119, v238
    v_mul_f32 v120, v120, v238
    v_mul_f32 v121, v121, v238
    v_mul_f32 v122, v122, v238
    v_mul_f32 v123, v123, v238
    v_mul_f32 v124, v124, v238
    v_mul_f32 v125, v125, v238
    v_mul_f32 v126, v126, v238
    v_mul_f32 v127, v127, v238
    v_mul_f32 v128, v128, v238
    v_mul_f32 v129, v129, v238
    v_mul_f32 v130, v130, v238
    v_mul_f32 v131, v131, v238
    v_mul_f32 v132, v132, v238
    v_mul_f32 v133, v133, v238
    v_mul_f32 v134, v134, v238
    v_mul_f32 v135, v135, v238
    v_mul_f32 v136, v136, v238
    v_mul_f32 v137, v137, v238
    v_mul_f32 v138, v138, v238
    v_mul_f32 v139, v139, v238
    v_mul_f32 v140, v140, v238
    v_mul_f32 v141, v141, v238
    v_mul_f32 v142, v142, v238
    v_mul_f32 v143, v143, v238
L_norescale:
    v_fma_f32 v208, v208, s28, -v244
    v_fma_f32 v209, v209, s28, -v244
    v_fma_f32 v210, v210, s28, -v244
    v_fma_f32 v211, v211, s28, -v244
    v_fma_f32 v212, v212, s28, -v245
    v_fma_f32 v213, v213, s28, -v245
    v_fma_f32 v214, v214, s28, -v245
    v_fma_f32 v215, v215, s28, -v245
    v_fma_f32 v216, v216, s28, -v246
    v_fma_f32 v217, v217, s28, -v246
    v_fma_f32 v218, v218, s28, -v246
    v_fma_f32 v219, v219, s28, -v246
    v_exp_f32 v208, v208
    v_exp_f32 v209, v209
    v_exp_f32 v210, v210
    v_exp_f32 v211, v211
    v_exp_f32 v212, v212
    v_exp_f32 v213, v213
    v_exp_f32 v214, v214
    v_exp_f32 v215, v215
    v_exp_f32 v216, v216
    v_exp_f32 v217, v217
    v_exp_f32 v218, v218
    v_exp_f32 v219, v219
    v_add_f32 v254, v208, v209
    v_cvt_pk_bf16_f32 v208, v208, v209
    v_cvt_pk_bf16_f32 v209, v210, v211
    v_add_f32 v210, v210, v211
    v_add_f32 v210, v210, v254
    v_add_f32 v255, v212, v213
    v_cvt_pk_bf16_f32 v212, v212, v213
    v_cvt_pk_bf16_f32 v213, v214, v215
    v_add_f32 v214, v214, v215
    v_add_f32 v214, v214, v255
    v_add_f32 v254, v216, v217
    v_cvt_pk_bf16_f32 v216, v216, v217
    v_cvt_pk_bf16_f32 v217, v218, v219
    v_add_f32 v218, v218, v219
    v_add_f32 v218, v218, v254
    v_fma_f32 v220, v220, s28, -v244
    v_fma_f32 v221, v221, s28, -v244
    v_fma_f32 v222, v222, s28, -v244
    v_fma_f32 v223, v223, s28, -v244
    v_fma_f32 v224, v224, s28, -v245
    v_fma_f32 v225, v225, s28, -v245
    v_fma_f32 v226, v226, s28, -v245
    v_fma_f32 v227, v227, s28, -v245
    v_fma_f32 v228, v228, s28, -v246
    v_fma_f32 v229, v229, s28, -v246
    v_fma_f32 v230, v230, s28, -v246
    v_fma_f32 v231, v231, s28, -v246
    v_exp_f32 v220, v220
    v_exp_f32 v221, v221
    v_exp_f32 v222, v222
    v_exp_f32 v223, v223
    v_exp_f32 v224, v224
    v_exp_f32 v225, v225
    v_exp_f32 v226, v226
    v_exp_f32 v227, v227
    v_exp_f32 v228, v228
    v_exp_f32 v229, v229
    v_exp_f32 v230, v230
    v_exp_f32 v231, v231
    v_add_f32 v254, v220, v221
    v_add_f32 v255, v222, v223
    v_add_f32 v210, v210, v254
    v_add_f32 v210, v210, v255
    v_add_f32 v254, v224, v225
    v_add_f32 v255, v226, v227
    v_add_f32 v214, v214, v254
    v_add_f32 v214, v214, v255
    v_add_f32 v254, v228, v229
    v_add_f32 v255, v230, v231
    v_add_f32 v218, v218, v254
    v_add_f32 v218, v218, v255
    ds_read_b64_tr_b16 v[232:233], v251 offset:0
    ds_read_b64_tr_b16 v[234:235], v251 offset:6144
    ds_read_b64_tr_b16 v[236:237], v251 offset:1024
    ds_read_b64_tr_b16 v[238:239], v251 offset:7168
    ds_read_b64_tr_b16 v[240:241], v251 offset:2048
    ds_read_b64_tr_b16 v[242:243], v251 offset:8192
    s_nop 3
    s_and_b32 s46, s29, 15
    s_cmp_eq_u32 s46, 0
    s_cbranch_scc1 L_pvb
    s_branch L_after
.section .rodata,"a"
.p2align 6
.amdhsa_kernel standalone__gqa_softmax__near_ridge_kernel
  .amdhsa_next_free_vgpr 256
  .amdhsa_next_free_sgpr 102
  .amdhsa_accum_offset 256
  .amdhsa_group_segment_fixed_size 0
  .amdhsa_kernarg_size 48
  .amdhsa_user_sgpr_count 2
  .amdhsa_user_sgpr_kernarg_segment_ptr 1
  .amdhsa_system_sgpr_workgroup_id_x 1
.end_amdhsa_kernel
```
